```python
import torch

def _softmax(x, axis=-1):
    return torch.softmax(x, dim=axis)
def _gelu(x):
    return torch.nn.functional.gelu(x, approximate="tanh")
def _silu(x):
    return torch.nn.functional.silu(x)
def _sigmoid(x):
    return torch.sigmoid(x)
def _layernorm(x, axis=-1, eps=1e-5):
    m = x.mean(dim=axis, keepdim=True)
    v = x.var(dim=axis, keepdim=True, unbiased=False)
    return (x - m) / torch.sqrt(v + eps)
def _scatter_add(tgt, idx, src, axis=0):
    return tgt.clone().index_add_(axis, idx, src)
def _segment_sum(src, seg, n):
    out = torch.zeros((n,) + src.shape[1:], dtype=src.dtype)
    return out.index_add_(0, seg, src)
def _pad(x, pw):
    flat = tuple(v for pair in reversed(pw) for v in pair)
    return torch.nn.functional.pad(x, flat)

kernel_name = 'gated_mix__ssm_conv_h3__spectral_fnet__prompt'

def setup_inputs():

    _w = (lambda a: (lambda t: t.to(torch.bfloat16) if t.is_floating_point() else t)(torch.as_tensor(a)))
    def _A_setup():
        B, S, D = 1, 2048, 512
        ks = 4
        return {
            "q": _w((lambda *s: torch.randn(*s, dtype=torch.bfloat16) * 0.05)(B, S, D)),
            "k": _w((lambda *s: torch.randn(*s, dtype=torch.bfloat16) * 3.2)(B, S, D)),
            "v": _w((lambda *s: torch.randn(*s, dtype=torch.bfloat16) * 3.2)(B, S, D)),
            "shift_k": _w((lambda *s: torch.randn(*s, dtype=torch.bfloat16) * 3.2)(D, ks) * 0.5),
            "ssm_k": _w((lambda *s: torch.randn(*s, dtype=torch.bfloat16) * 3.2)(D, S) * (1.0 / S ** 0.5)),
            "ssm_D": _w((lambda *s: torch.randn(*s, dtype=torch.bfloat16) * 3.2)(D)),
        }
    _A_in = _A_setup()

    def _B_setup():
        B, S, D = 1, 2048, 512
        ns = torch.arange(S)[:, None] * torch.arange(S)[None, :]
        nd = torch.arange(D)[:, None] * torch.arange(D)[None, :]
        Ws_re = torch.cos(-2.0 * torch.pi * ns / S).to(float)
        Ws_im = torch.sin(-2.0 * torch.pi * ns / S).to(float)
        Wd_re = torch.cos(-2.0 * torch.pi * nd / D).to(float)
        Wd_im = torch.sin(-2.0 * torch.pi * nd / D).to(float)
        return {
            "x": _w((lambda *s: torch.randn(*s, dtype=torch.bfloat16) * 0.05)(B, S, D)),
            "dft_seq_re": _w(Ws_re),
            "dft_seq_im": _w(Ws_im),
            "dft_hid_re": _w(Wd_re),
            "dft_hid_im": _w(Wd_im),
        }
    _B_in = _B_setup()

    return {
        "A_q": _A_in["q"],
        "A_k": _A_in["k"],
        "A_v": _A_in["v"],
        "A_shift_k": _A_in["shift_k"],
        "A_ssm_k": _A_in["ssm_k"],
        "A_ssm_D": _A_in["ssm_D"],
        "B_x": _B_in["x"],
        "B_dft_seq_re": _B_in["dft_seq_re"],
        "B_dft_seq_im": _B_in["dft_seq_im"],
        "B_dft_hid_re": _B_in["dft_hid_re"],
        "B_dft_hid_im": _B_in["dft_hid_im"],
        "gate_w": _w((lambda *s: torch.randn(*s, dtype=torch.bfloat16) * 0.05)(512) * 16.0),
    }

def reference(A_q, A_k, A_v, A_shift_k, A_ssm_k, A_ssm_D, B_x, B_dft_seq_re, B_dft_seq_im, B_dft_hid_re, B_dft_hid_im, gate_w):
    def _A_ref(q, k, v, shift_k, ssm_k, ssm_D):
        B, S, D = q.shape
        ks = shift_k.shape[-1]
        k_pad = _pad(k, ((0, 0), (ks - 1, 0), (0, 0)))
        k_shift = torch.zeros_like(k)
        for t in range(ks):
            k_shift = k_shift + k_pad[:, t:t + S, :] * shift_k[:, ks - 1 - t][None, None, :]
        kv = k_shift * v
        L = 2 * S
        kv_pad = _pad(kv, ((0, 0), (0, S), (0, 0)))
        kf_pad = _pad(ssm_k, ((0, 0), (0, S)))
        kv_f = (lambda x, axes=(-2,-1): torch.fft.rfft2(x.float(), dim=axes))(kv_pad[:, None, :, :], axes=(1, 2))
        kf_f = (lambda x, axes=(-2,-1): torch.fft.rfft2(x.float(), dim=axes))(kf_pad[:, None, :], axes=(1, 2))
        kf_f = (lambda x, *d: x.permute(*d))(kf_f, 1, 2, 0)
        y_f = kv_f * kf_f[None, :, :, :]
        y = (lambda x, s, axes=(-2,-1): torch.fft.irfft2(x, s=s, dim=axes).to(torch.bfloat16))(y_f, (1, L), axes=(1, 2))[:, 0, :S, :]
        y = y + kv * ssm_D[None, None, :]
        return q * y

    def _B_ref(x, dft_seq_re, dft_seq_im, dft_hid_re, dft_hid_im):
        a = torch.einsum("bsd,ed->bse", x, dft_hid_re)
        b = torch.einsum("bsd,ed->bse", x, dft_hid_im)
        y = torch.einsum("ts,bse->bte", dft_seq_re, a) - torch.einsum("ts,bse->bte", dft_seq_im, b)
        return y

    x = A_q
    g = _sigmoid((x * gate_w).sum(-1, keepdims=True))
    a = _A_ref(x, A_k, A_v, A_shift_k, A_ssm_k, A_ssm_D)
    b = _B_ref(x, B_dft_seq_re, B_dft_seq_im, B_dft_hid_re, B_dft_hid_im)
    return g * a + (1 - g) * b
```

```asm
; @launch grid=(256,1,1) block=(512,1,1) lds=77312
.amdgcn_target "amdgcn-amd-amdhsa--gfx950"
.text
.globl gated_mix__ssm_conv_h3__spectral_fnet__prompt_kernel
.p2align 8
.type gated_mix__ssm_conv_h3__spectral_fnet__prompt_kernel,@function
gated_mix__ssm_conv_h3__spectral_fnet__prompt_kernel:
    s_load_dwordx16 s[16:31], s[0:1], 0
    s_load_dwordx8 s[32:39], s[0:1], 88
    s_cmp_ge_u32 s2, 256
    s_cbranch_scc1 L_end
    s_getpc_b64 s[40:41]
    s_add_u32 s4, s2, 1
    s_and_b32 s4, s4, 7
    s_lshr_b32 s5, s2, 3
    v_lshrrev_b32 v2, 6, v0
    s_lshl_b32 s3, s5, 9
    v_lshl_add_u32 v1, v2, 6, s3
    v_readfirstlane_b32 s7, v2
    global_load_dword v255, v1, s[40:41]
    v_and_b32 v1, 63, v0
    v_and_b32 v0, 255, v0
    s_and_b32 s6, s7, 3
    v_lshlrev_b32 v46, 2, v0
    v_mov_b32 v45, 0
    ds_write_b32 v46, v45 offset:0
    s_mov_b32 s10, 0x200000
    s_mov_b32 s11, 0x20000
    s_cmp_ge_u32 s7, 4
    s_cbranch_scc1 L_roleA
    s_lshr_b32 s7, s5, 4
    s_and_b32 s3, s5, 15
    s_lshl4_add_u32 s40, s4, s3
    v_and_b32 v2, 3, v0
    v_bfe_u32 v3, v0, 2, 1
    v_lshl_add_u32 v2, v2, 1, v3
    v_and_b32 v3, 8, v0
    v_add_u32 v2, v2, v3
    s_sub_u32 s63, 256, s40
    s_cmp_eq_u32 s40, 0
    s_cselect_b32 s63, 128, s63
    s_sub_u32 s3, s63, s40
    v_lshrrev_b32 v3, 5, v1
    v_mul_u32_u24 v240, s3, v3
    v_add_u32 v240, s40, v240
    v_and_b32 v242, 16, v0
    v_lshl_add_u32 v241, v242, 6, v240
    s_lshl_b32 s41, s6, 8
    v_lshl_add_u32 v3, v2, 4, s41
    v_lshl_add_u32 v2, v241, 10, v3
    s_lshl_b32 s48, s7, 19
    s_xor_b32 s49, s48, 0x40000
    s_xor_b32 s50, s48, 0x80000
    s_xor_b32 s51, s48, 0xc0000
    v_mov_b32 v244, s6
    v_mov_b32 v245, 1
    v_mov_b32_e64 v246, 0
    s_waitcnt lgkmcnt(0)
    s_mov_b64 s[8:9], s[16:17]
    buffer_load_dwordx4 v[224:227], v2, s[8:11], s48 offen
    buffer_load_dwordx4 v[228:231], v2, s[8:11], s49 offen
    buffer_load_dwordx4 v[72:75], v2, s[8:11], s50 offen
    buffer_load_dwordx4 v[76:79], v2, s[8:11], s51 offen
    global_load_dwordx4 v[220:223], v3, s[32:33]
    s_barrier
    s_branch L_roleB
L_roleA:
    s_lshl_b32 s40, s5, 16
    s_lshl_b32 s3, s4, 7
    s_add_u32 s40, s40, s3
    v_lshrrev_b32 v3, 5, v0
    v_and_b32 v4, 31, v0
    v_lshl_add_u32 v3, v3, 13, s40
    v_lshl_add_u32 v2, v4, 2, v3
    v_add_u32 v3, -3072, v2
    s_lshl_b32 s3, s4, 9
    v_lshl_add_u32 v5, v4, 4, s3
    s_lshl_b32 s41, s4, 5
    s_add_u32 s41, s41, s5
    s_lshl_b32 s42, s41, 13
    s_add_u32 s43, s42, 4096
    s_lshl_b32 s41, s41, 2
    s_movk_i32 s7, 4096
    v_mov_b32 v49, s41
    s_mov_b32 s50, 0x200000
    s_mov_b32 s51, 0x20000
    s_waitcnt lgkmcnt(0)
    s_mov_b64 s[8:9], s[18:19]
    s_mov_b32 exec_hi, 0
    buffer_load_dword v10, v3, s[8:11], 0 offen offset:0 nt
    buffer_load_dword v11, v3, s[8:11], 0 offen offset:1024 nt
    buffer_load_dword v12, v3, s[8:11], 0 offen offset:2048 nt
    s_mov_b64 exec, -1
    buffer_load_dword v13, v2, s[8:11], 0 offen offset:0 nt
    buffer_load_dword v14, v2, s[8:11], 0 offen offset:1024 nt
    buffer_load_dword v15, v2, s[8:11], 0 offen offset:2048 nt
    buffer_load_dword v16, v2, s[8:11], 0 offen offset:3072 nt
    buffer_load_dword v17, v2, s[8:11], s7 offen offset:0 nt
    buffer_load_dword v18, v2, s[8:11], s7 offen offset:1024 nt
    buffer_load_dword v19, v2, s[8:11], s7 offen offset:2048 nt
    buffer_load_dword v20, v2, s[8:11], s7 offen offset:3072 nt
    global_load_dwordx4 v[30:33], v5, s[22:23]
    global_load_dword v9, v45, s[38:39] sc1
    global_load_dword v49, v49, s[26:27]
    s_barrier
    s_mov_b64 s[48:49], s[24:25]
    s_add_u32 s20, s20, s7
    s_addc_u32 s21, s21, 0
    s_and_b32 s28, s5, 15
    s_lshr_b32 s29, s5, 4
    s_lshl3_add_u32 s30, s28, s4
    s_lshl_b32 s30, s30, 7
    s_lshl_b32 s3, s29, 20
    s_add_u32 s3, s3, s30
    s_add_u32 s12, s34, s3
    s_addc_u32 s13, s35, 0
    s_lshl_b32 s3, s4, 12
    s_add_u32 s3, s3, 4096
    s_add_u32 s58, s38, s3
    s_addc_u32 s59, s39, 0
    s_lshl_b32 s3, s5, 7
    v_and_b32 v253, 64, v0
    v_add_u32 v253, s3, v253
    v_lshlrev_b32 v6, 4, v0
    v_and_b32 v252, 0xfc, v0
    v_lshlrev_b32 v252, 12, v252
    v_and_b32_e64 v254, 3, v0
    v_lshl_add_u32 v252, v254, 5, v252
    buffer_load_dwordx4 v[36:39], v6, s[48:51], s42 offen offset:4 nt
    buffer_load_dword v34, v6, s[48:51], s42 offen
    global_load_dword v22, v2, s[20:21] offset:-4096 nt
    global_load_dword v23, v2, s[20:21] offset:-3072 nt
    global_load_dword v24, v2, s[20:21] offset:-2048 nt
    global_load_dword v25, v2, s[20:21] offset:-1024 nt
    global_load_dword v26, v2, s[20:21] offset:0 nt
    global_load_dword v27, v2, s[20:21] offset:1024 nt
    global_load_dword v28, v2, s[20:21] offset:2048 nt
    global_load_dword v29, v2, s[20:21] offset:3072 nt
    buffer_load_dwordx4 v[40:43], v6, s[48:51], s43 offen offset:4 nt
    buffer_load_dword v35, v6, s[48:51], s43 offen
    global_load_dword v253, v253, s[58:59] sc1
    global_load_dword v254, v252, s[12:13]
    s_mul_i32 s3, s6, 4160
    v_min_u32 v48, 6, v1
    v_lshl_add_u32 v47, v48, 2, s3
    ds_write_b32 v47, v45 offset:9216
    s_lshl_b32 s47, s6, 11
    s_lshl2_add_u32 s60, s5, s6
    s_lshl_b32 s31, s60, 7
    s_add_u32 s31, s31, s4
    s_lshl_b32 s31, s31, 7
    s_add_u32 s54, s34, s31
    s_addc_u32 s55, s35, 0
    s_lshl_b32 s3, s29, 6
    s_add_u32 s30, s30, s3
    s_add_u32 s52, s34, s30
    s_addc_u32 s53, s35, 0
    s_add_u32 s56, s52, 0x3fc00
    s_addc_u32 s57, s53, 0
    s_lshl2_add_u32 s33, s28, s6
    s_lshl_b32 s33, s33, 5
    s_add_u32 s33, s33, s4
    s_lshl_b32 s33, s33, 7
    s_add_u32 s33, s33, s3
    s_add_u32 s16, s34, s33
    s_addc_u32 s17, s35, 0
    v_and_b32 v233, 48, v6
    v_and_b32 v5, 60, v1
    s_lshl_b32 s3, s6, 19
    v_lshl_add_u32 v232, v5, 12, s3
    v_add_u32 v232, v232, v233
    v_and_b32 v47, 28, v1
    v_lshl_add_u32 v233, v47, 16, v233
    v_and_b32 v47, 32, v1
    v_lshl_add_u32 v233, v47, 5, v233
    s_lshl2_add_u32 s3, s29, s6
    s_lshl_b32 s3, s3, 6
    v_and_b32 v237, 15, v0
    v_lshl_add_u32 v237, v237, 2, s3
    v_lshlrev_b32 v44, 3, v1
    v_lshrrev_b32 v47, 1, v1
    v_and_b32 v47, 16, v47
    v_and_b32 v48, 48, v44
    v_xor_b32 v47, v47, v48
    v_lshl_add_u32 v47, v4, 6, v47
    v_add_u32 v47, s47, v47
    v_xor_b32 v48, 32, v47
    v_lshl_add_u32 v21, v1, 4, s47
    v_add_u32 v8, v1, v1
    v_xor_b32 v8, v8, v6
    s_lshl_b32 s3, s5, 4
    v_xor_b32 v8, s3, v8
    v_and_b32 v8, 48, v8
    v_lshl_add_u32 v8, v5, 8, v8
    s_lshl_b32 s60, s60, 2
    v_mov_b32 v7, s60
    s_add_u32 m0, s47, 1024
    v_and_b32 v238, 15, v0
    v_lshrrev_b32 v235, 4, v1
    v_sub_u32 v238, v238, v235
    s_and_b32 s41, s6, 1
    s_lshl_b32 s41, s41, 3
    s_sub_u32 s41, 16, s41
    v_add_u32 v238, s41, v238
    s_or_b32 s3, s6, 1
    s_lshl_b32 s3, s3, 4
    v_lshlrev_b32 v239, 2, v238
    v_xor_b32 v239, s3, v239
    v_and_b32 v239, 48, v239
    v_lshl_add_u32 v248, v238, 6, v239
    v_xor_b32 v249, 16, v248
    v_add_u32 v238, -4, v238
    v_lshlrev_b32 v239, 2, v238
    v_xor_b32 v239, s3, v239
    v_and_b32 v239, 48, v239
    v_lshl_add_u32 v250, v238, 6, v239
    v_xor_b32 v251, 16, v250
    s_mul_i32 s3, s6, 8704
    v_add_u32 v236, v235, v1
    v_lshl_add_u32 v236, v236, 4, s3
    s_lshl_b32 s3, s6, 6
    v_mul_u32_u24 v3, 272, v4
    v_lshrrev_b32 v5, 1, v1
    v_and_b32 v5, 16, v5
    v_add3_u32 v3, v3, v5, s3
    s_lshl1_add_u32 s60, s5, s3
    s_lshl_b32 s60, s60, 1
    s_lshr_b32 s61, s6, 1
    s_mul_i32 s61, s61, 7808
    s_lshl_b32 s41, s6, 8
    s_add_u32 s61, s61, s41
    s_add_u32 s61, s61, 9216
    v_and_b32 v234, 1, v0
    v_mul_u32_u24 v234, 4158, v234
    v_lshl_add_u32 v234, v1, 1, v234
    v_add_u32 v234, s61, v234
    s_setprio 1
    s_waitcnt vmcnt(14)
    v_mov_b32 v96, v18
    v_mov_b32 v97, v19
    v_mov_b32 v98, v20
    v_permlane32_swap_b32 v10, v96
    v_permlane32_swap_b32 v11, v97
    v_permlane32_swap_b32 v12, v98
    v_lshlrev_b32 v72, 16, v30
    v_lshlrev_b32 v73, 16, v32
    v_and_b32 v74, 0xffff0000, v30
    v_and_b32 v75, 0xffff0000, v32
    v_lshlrev_b32 v76, 16, v31
    v_lshlrev_b32 v77, 16, v33
    v_and_b32 v78, 0xffff0000, v31
    v_and_b32 v79, 0xffff0000, v33
    v_lshlrev_b32 v50, 16, v10
    v_and_b32 v51, 0xffff0000, v10
    v_lshlrev_b32 v52, 16, v11
    v_and_b32 v53, 0xffff0000, v11
    v_lshlrev_b32 v54, 16, v12
    v_and_b32 v55, 0xffff0000, v12
    v_lshlrev_b32 v56, 16, v13
    v_and_b32 v57, 0xffff0000, v13
    v_lshlrev_b32 v58, 16, v14
    v_and_b32 v59, 0xffff0000, v14
    v_lshlrev_b32 v60, 16, v15
    v_and_b32 v61, 0xffff0000, v15
    v_lshlrev_b32 v62, 16, v16
    v_and_b32 v63, 0xffff0000, v16
    v_lshlrev_b32 v64, 16, v17
    v_and_b32 v65, 0xffff0000, v17
    v_lshlrev_b32 v66, 16, v18
    v_and_b32 v67, 0xffff0000, v18
    v_lshlrev_b32 v68, 16, v19
    v_and_b32 v69, 0xffff0000, v19
    v_lshlrev_b32_e64 v70, 16, v20
    v_and_b32 v71, 0xffff0000, v20
    v_pk_mul_f32 v[80:81], v[50:51], v[78:79]
    v_pk_mul_f32 v[82:83], v[52:53], v[78:79]
    v_pk_mul_f32 v[84:85], v[54:55], v[78:79]
    v_pk_mul_f32 v[86:87], v[56:57], v[78:79]
    v_pk_mul_f32 v[88:89], v[58:59], v[78:79]
    v_pk_mul_f32 v[90:91], v[60:61], v[78:79]
    v_pk_mul_f32 v[92:93], v[62:63], v[78:79]
    v_pk_mul_f32 v[94:95], v[64:65], v[78:79]
    v_pk_fma_f32 v[80:81], v[52:53], v[76:77], v[80:81]
    v_pk_fma_f32 v[82:83], v[54:55], v[76:77], v[82:83]
    v_pk_fma_f32 v[84:85], v[56:57], v[76:77], v[84:85]
    v_pk_fma_f32 v[86:87], v[58:59], v[76:77], v[86:87]
    v_pk_fma_f32 v[88:89], v[60:61], v[76:77], v[88:89]
    v_pk_fma_f32 v[90:91], v[62:63], v[76:77], v[90:91]
    v_pk_fma_f32 v[92:93], v[64:65], v[76:77], v[92:93]
    v_pk_fma_f32 v[94:95], v[66:67], v[76:77], v[94:95]
    v_pk_fma_f32 v[80:81], v[54:55], v[74:75], v[80:81]
    v_pk_fma_f32 v[82:83], v[56:57], v[74:75], v[82:83]
    v_pk_fma_f32 v[84:85], v[58:59], v[74:75], v[84:85]
    v_pk_fma_f32 v[86:87], v[60:61], v[74:75], v[86:87]
    v_pk_fma_f32 v[88:89], v[62:63], v[74:75], v[88:89]
    v_pk_fma_f32 v[90:91], v[64:65], v[74:75], v[90:91]
    v_pk_fma_f32 v[92:93], v[66:67], v[74:75], v[92:93]
    v_pk_fma_f32 v[94:95], v[68:69], v[74:75], v[94:95]
    v_pk_fma_f32 v[80:81], v[56:57], v[72:73], v[80:81]
    v_pk_fma_f32 v[82:83], v[58:59], v[72:73], v[82:83]
    v_pk_fma_f32 v[84:85], v[60:61], v[72:73], v[84:85]
    v_pk_fma_f32 v[86:87], v[62:63], v[72:73], v[86:87]
    v_pk_fma_f32 v[88:89], v[64:65], v[72:73], v[88:89]
    v_pk_fma_f32 v[90:91], v[66:67], v[72:73], v[90:91]
    v_pk_fma_f32 v[92:93], v[68:69], v[72:73], v[92:93]
    v_pk_fma_f32 v[94:95], v[70:71], v[72:73], v[94:95]
    v_readfirstlane_b32 s44, v9
    v_readfirstlane_b32 s46, v49
    s_mov_b32 s96, 0
    s_getreg_b32 s3, hwreg(HW_REG_XCC_ID, 0, 4)
    s_mul_i32 s44, s44, 1664525
    s_add_u32 s44, s44, 1013904223
    s_add_u32 s45, s44, s3
    s_add_u32 s45, s45, 1
    v_mov_b32 v9, s45
    v_mov_b32 v20, v44
    v_mov_b32 v10, v234
    v_mov_b32 v2, v236
    v_mov_b64 v[18:19], v[232:233]
    v_mov_b32 v30, v237
    v_mov_b64 v[14:15], v[248:249]
    v_mov_b64 v[16:17], v[250:251]
    v_add_u32 v11, 1024, v234
    v_add_u32 v12, 2048, v234
    v_add_u32 v13, 3072, v234
    s_waitcnt vmcnt(12)
    s_nop 0
    ds_write_b128 v6, v[36:39] offset:13408
    v_alignbit_b32 v52, v36, v34, 16
    v_alignbit_b32 v53, v37, v36, 16
    v_alignbit_b32 v54, v38, v37, 16
    v_alignbit_b32 v55, v39, v38, 16
    ds_write_b128 v6, v[52:55] offset:9248
    s_cmp_lg_u32 s6, 0
    s_cbranch_scc1 L_a_h0
    s_mov_b64 exec, 1
    s_lshl_b32 s3, s46, 16
    v_lshlrev_b32 v60, 16, v34
    v_add_f32 v60, s3, v60
    v_cvt_pk_bf16_f32 v60, 0, v60
    s_mov_b32 s3, 0x07060302
    v_perm_b32 v62, v34, v60, s3
    ds_write_b32 v6, v60 offset:9244
    ds_write_b32 v6, v62 offset:13404
    s_mov_b64 exec, -1
L_a_h0:
    s_waitcnt vmcnt(8)
    v_lshlrev_b32 v96, 16, v22
    v_and_b32 v97, 0xffff0000, v22
    v_pk_mul_f32 v[80:81], v[80:81], v[96:97]
    v_lshlrev_b32 v98, 16, v23
    v_and_b32 v99, 0xffff0000, v23
    v_pk_mul_f32 v[82:83], v[82:83], v[98:99]
    v_cvt_pk_bf16_f32 v115, v82, v80
    v_cvt_pk_bf16_f32 v119, v83, v81
    v_lshlrev_b32 v100, 16, v24
    v_and_b32 v101, 0xffff0000, v24
    v_pk_mul_f32 v[84:85], v[84:85], v[100:101]
    v_lshlrev_b32 v102, 16, v25
    v_and_b32 v103, 0xffff0000, v25
    v_pk_mul_f32 v[86:87], v[86:87], v[102:103]
    v_cvt_pk_bf16_f32 v114, v86, v84
    v_cvt_pk_bf16_f32 v118, v87, v85
    s_waitcnt vmcnt(4)
    v_lshlrev_b32 v104, 16, v26
    v_and_b32 v105, 0xffff0000, v26
    v_pk_mul_f32 v[88:89], v[88:89], v[104:105]
    v_lshlrev_b32 v106, 16, v27
    v_and_b32 v107, 0xffff0000, v27
    v_pk_mul_f32 v[90:91], v[90:91], v[106:107]
    v_cvt_pk_bf16_f32 v113, v90, v88
    v_cvt_pk_bf16_f32 v117, v91, v89
    v_lshlrev_b32 v108, 16, v28
    v_and_b32 v109, 0xffff0000, v28
    v_pk_mul_f32 v[92:93], v[92:93], v[108:109]
    v_lshlrev_b32_e64 v110, 16, v29
    v_and_b32 v111, 0xffff0000, v29
    v_pk_mul_f32 v[94:95], v[94:95], v[110:111]
    v_cvt_pk_bf16_f32 v112, v94, v92
    v_cvt_pk_bf16_f32 v116, v95, v93
    ds_write_b128 v47, v[112:115] offset:25856
    ds_write_b128 v48, v[116:119] offset:25856
    ds_read_b128 v[240:243], v21 offset:25856
    ds_read_b128 v[244:247], v21 offset:26880
    s_waitcnt lgkmcnt(1)
    global_store_dwordx4 v8, v[240:243], s[54:55]
    s_waitcnt lgkmcnt(0)
    global_store_dwordx4 v8, v[244:247], s[54:55] offset:64
    v_mov_b32 v26, 0
    v_mov_b32 v27, s44
    ds_write_b32 v26, v27 offset:16
    s_waitcnt vmcnt(4)
    s_nop 0
    ds_write_b128 v6, v[40:43] offset:21728
    v_alignbit_b32 v56, v40, v35, 16
    v_alignbit_b32 v57, v41, v40, 16
    v_alignbit_b32 v58, v42, v41, 16
    v_alignbit_b32 v59, v43, v42, 16
    ds_write_b128 v6, v[56:59] offset:17568
    s_cmp_lg_u32 s6, 0
    s_cbranch_scc1 L_a_h1
    s_mov_b64 exec, 1
    s_and_b32 s3, s46, 0xffff0000
    v_lshlrev_b32 v61, 16, v35
    v_add_f32_e64 v61, s3, v61
    v_cvt_pk_bf16_f32 v61, 0, v61
    s_mov_b32 s3, 0x07060302
    v_perm_b32 v63, v35, v61, s3
    ds_write_b32 v6, v61 offset:17564
    ds_write_b32 v6, v63 offset:21724
    s_mov_b64 exec, -1
L_a_h1:
    v_mov_b32 v5, s6
    v_mov_b32 v4, 1
    ds_write_b8 v5, v4 offset:0
    s_mov_b64 exec, 1
    s_waitcnt vmcnt(0)
    global_store_dword v7, v9, s[58:59]
    s_mov_b64 exec, -1
    s_mov_b32 s3, 0
    global_load_dwordx2 v[22:23], v20, s[58:59] sc1
    s_mov_b32 s3, 0
L_a_hw:
    ds_read_b32 v28, v26 offset:0
    s_waitcnt lgkmcnt(0)
    v_cmp_ne_u32 vcc, 0x01010101, v28
    s_cbranch_vccnz L_a_hw
    ds_read2_b32 v[32:33], v10 offset0:0 offset1:1
    ds_read2_b32 v[34:35], v10 offset0:2 offset1:3
    ds_read2_b32 v[36:37], v10 offset0:128 offset1:129
    ds_read2_b32 v[38:39], v10 offset0:130 offset1:131
    ds_read2_b32 v[40:41], v11 offset0:0 offset1:1
    ds_read2_b32 v[42:43], v11 offset0:2 offset1:3
    ds_read2_b32 v[44:45], v11 offset0:128 offset1:129
    ds_read2_b32 v[46:47], v11 offset0:130 offset1:131
    ds_read2_b32 v[48:49], v12 offset0:0 offset1:1
    ds_read2_b32 v[50:51], v12 offset0:2 offset1:3
    ds_read2_b32 v[52:53], v12 offset0:128 offset1:129
    ds_read2_b32 v[54:55], v12 offset0:130 offset1:131
    ds_read2_b32 v[56:57], v13 offset0:0 offset1:1
    ds_read2_b32 v[58:59], v13 offset0:2 offset1:3
    ds_read2_b32 v[60:61], v13 offset0:128 offset1:129
    ds_read2_b32 v[62:63], v13 offset0:130 offset1:131
    s_branch L_a_pu1
L_a_pu:
    global_load_dwordx2 v[22:23], v20, s[58:59] sc1
L_a_pu1:
    s_waitcnt vmcnt(0)
    v_cmp_ne_u32 vcc, s45, v22
    v_cmp_ne_u32 s[40:41], s45, v23
    s_nop 0
    s_or_b64 vcc, vcc, s[40:41]
    s_cbranch_scc0 L_a_pu_ok
    s_add_u32 s3, s3, 1
    s_cmp_lt_u32 s3, 64
    s_cbranch_scc1 L_a_pu
    s_branch L_a_far
L_a_pu_ok:
    global_load_lds_dwordx4 v18, s[52:53] sc1
    global_load_lds_dwordx4 v18, s[56:57] offset:1024 sc1
    v_mov_b32 v29, s60
    v_mov_b32 v5, s6
    v_mov_b32_e64 v4, 1
    s_waitcnt vmcnt(0)
    s_barrier
    ds_read_b128 v[160:163], v14 offset:0
    ds_read_b128 v[164:167], v14 offset:1024
    ds_read_b128 v[168:171], v14 offset:2048
    ds_read_b128 v[172:175], v14 offset:3072
    ds_read_b128 v[176:179], v14 offset:4096
    ds_read_b128 v[180:183], v14 offset:5120
    ds_read_b128 v[184:187], v14 offset:6144
    ds_read_b128 v[188:191], v14 offset:7168
    s_waitcnt lgkmcnt(7)
    v_mfma_f32_16x16x32_bf16 v[224:227], v[160:163], v[32:35], 0
    s_waitcnt lgkmcnt(6)
    v_mfma_f32_16x16x32_bf16 v[228:231], v[164:167], v[32:35], 0
    v_mfma_f32_16x16x32_bf16 v[228:231], v[160:163], v[36:39], v[228:231]
    s_waitcnt lgkmcnt(5)
    v_mfma_f32_16x16x32_bf16 v[232:235], v[168:171], v[32:35], 0
    v_mfma_f32_16x16x32_bf16 v[232:235], v[164:167], v[36:39], v[232:235]
    v_mfma_f32_16x16x32_bf16 v[232:235], v[160:163], v[40:43], v[232:235]
    s_waitcnt lgkmcnt(4)
    v_mfma_f32_16x16x32_bf16 v[236:239], v[172:175], v[32:35], 0
    v_mfma_f32_16x16x32_bf16 v[236:239], v[168:171], v[36:39], v[236:239]
    ds_read_b128 v[192:195], v15 offset:0
    v_mfma_f32_16x16x32_bf16 v[236:239], v[164:167], v[40:43], v[236:239]
    ds_read2_b32 v[64:65], v10 offset0:4 offset1:5
    v_mfma_f32_16x16x32_bf16 v[236:239], v[160:163], v[44:47], v[236:239]
    ds_read2_b32 v[66:67], v10 offset0:6 offset1:7
    s_waitcnt lgkmcnt(6)
    s_nop 0
    v_mfma_f32_16x16x32_bf16 v[240:243], v[176:179], v[32:35], 0
    ds_read_b128 v[196:199], v15 offset:1024
    v_mfma_f32_16x16x32_bf16 v[240:243], v[172:175], v[36:39], v[240:243]
    ds_read2_b32 v[68:69], v10 offset0:132 offset1:133
    v_mfma_f32_16x16x32_bf16 v[240:243], v[168:171], v[40:43], v[240:243]
    ds_read2_b32 v[70:71], v10 offset0:134 offset1:135
    v_mfma_f32_16x16x32_bf16 v[240:243], v[164:167], v[44:47], v[240:243]
    ds_read_b128 v[200:203], v15 offset:2048
    v_mfma_f32_16x16x32_bf16 v[240:243], v[160:163], v[48:51], v[240:243]
    ds_read2_b32 v[72:73], v11 offset0:4 offset1:5
    s_waitcnt lgkmcnt(10)
    s_nop 0
    v_mfma_f32_16x16x32_bf16 v[244:247], v[180:183], v[32:35], 0
    ds_read2_b32 v[74:75], v11 offset0:6 offset1:7
    v_mfma_f32_16x16x32_bf16 v[244:247], v[176:179], v[36:39], v[244:247]
    ds_read_b128 v[204:207], v15 offset:3072
    v_mfma_f32_16x16x32_bf16 v[244:247], v[172:175], v[40:43], v[244:247]
    ds_read2_b32 v[76:77], v11 offset0:132 offset1:133
    v_mfma_f32_16x16x32_bf16 v[244:247], v[168:171], v[44:47], v[244:247]
    ds_read2_b32 v[78:79], v11 offset0:134 offset1:135
    v_mfma_f32_16x16x32_bf16 v[244:247], v[164:167], v[48:51], v[244:247]
    ds_read_b128 v[208:211], v15 offset:4096
    v_mfma_f32_16x16x32_bf16 v[244:247], v[160:163], v[52:55], v[244:247]
    ds_read2_b32 v[80:81], v12 offset0:4 offset1:5
    s_waitcnt lgkmcnt(15)
    s_nop 0
    v_mfma_f32_16x16x32_bf16 v[248:251], v[184:187], v[32:35], 0
    ds_read2_b32 v[82:83], v12 offset0:6 offset1:7
    v_mfma_f32_16x16x32_bf16 v[248:251], v[180:183], v[36:39], v[248:251]
    ds_read_b128 v[212:215], v15 offset:5120
    v_mfma_f32_16x16x32_bf16 v[248:251], v[176:179], v[40:43], v[248:251]
    ds_read2_b32 v[84:85], v12 offset0:132 offset1:133
    v_mfma_f32_16x16x32_bf16 v[248:251], v[172:175], v[44:47], v[248:251]
    ds_read2_b32 v[86:87], v12 offset0:134 offset1:135
    v_mfma_f32_16x16x32_bf16 v[248:251], v[168:171], v[48:51], v[248:251]
    ds_read_b128 v[216:219], v15 offset:6144
    v_mfma_f32_16x16x32_bf16 v[248:251], v[164:167], v[52:55], v[248:251]
    ds_read2_b32 v[88:89], v13 offset0:4 offset1:5
    v_mfma_f32_16x16x32_bf16 v[248:251], v[160:163], v[56:59], v[248:251]
    ds_read2_b32 v[90:91], v13 offset0:6 offset1:7
    s_waitcnt lgkmcnt(15)
    s_nop 0
    v_mfma_f32_16x16x32_bf16 v[252:255], v[188:191], v[32:35], 0
    ds_read_b128 v[220:223], v15 offset:7168
    v_mfma_f32_16x16x32_bf16 v[252:255], v[184:187], v[36:39], v[252:255]
    ds_read2_b32 v[92:93], v13 offset0:132 offset1:133
    v_mfma_f32_16x16x32_bf16 v[252:255], v[180:183], v[40:43], v[252:255]
    ds_read2_b32 v[94:95], v13 offset0:134 offset1:135
    v_mfma_f32_16x16x32_bf16 v[252:255], v[176:179], v[44:47], v[252:255]
    v_mfma_f32_16x16x32_bf16 v[252:255], v[172:175], v[48:51], v[252:255]
    v_mfma_f32_16x16x32_bf16 v[252:255], v[168:171], v[52:55], v[252:255]
    v_mfma_f32_16x16x32_bf16 v[252:255], v[164:167], v[56:59], v[252:255]
    v_mfma_f32_16x16x32_bf16 v[252:255], v[160:163], v[60:63], v[252:255]
    s_waitcnt lgkmcnt(0)
    s_nop 0
    v_mfma_f32_16x16x32_bf16 v[224:227], v[192:195], v[64:67], v[224:227]
    v_mfma_f32_16x16x32_bf16 v[228:231], v[196:199], v[64:67], v[228:231]
    ds_read_b128 v[160:163], v16 offset:0
    v_mfma_f32_16x16x32_bf16 v[228:231], v[192:195], v[68:71], v[228:231]
    ds_read2_b32 v[96:97], v10 offset0:32 offset1:33
    v_mfma_f32_16x16x32_bf16 v[232:235], v[200:203], v[64:67], v[232:235]
    ds_read2_b32 v[98:99], v10 offset0:34 offset1:35
    v_mfma_f32_16x16x32_bf16 v[232:235], v[196:199], v[68:71], v[232:235]
    ds_read_b128 v[164:167], v16 offset:1024
    v_mfma_f32_16x16x32_bf16 v[232:235], v[192:195], v[72:75], v[232:235]
    ds_read2_b32 v[100:101], v10 offset0:160 offset1:161
    v_mfma_f32_16x16x32_bf16 v[236:239], v[204:207], v[64:67], v[236:239]
    ds_read2_b32 v[102:103], v10 offset0:162 offset1:163
    v_mfma_f32_16x16x32_bf16 v[236:239], v[200:203], v[68:71], v[236:239]
    ds_read_b128 v[168:171], v16 offset:2048
    v_mfma_f32_16x16x32_bf16 v[236:239], v[196:199], v[72:75], v[236:239]
    ds_read2_b32 v[104:105], v11 offset0:32 offset1:33
    v_mfma_f32_16x16x32_bf16 v[236:239], v[192:195], v[76:79], v[236:239]
    ds_read2_b32 v[106:107], v11 offset0:34 offset1:35
    v_mfma_f32_16x16x32_bf16 v[240:243], v[208:211], v[64:67], v[240:243]
    ds_read_b128 v[172:175], v16 offset:3072
    v_mfma_f32_16x16x32_bf16 v[240:243], v[204:207], v[68:71], v[240:243]
    ds_read2_b32 v[108:109], v11 offset0:160 offset1:161
    v_mfma_f32_16x16x32_bf16 v[240:243], v[200:203], v[72:75], v[240:243]
    ds_read2_b32 v[110:111], v11 offset0:162 offset1:163
    v_mfma_f32_16x16x32_bf16 v[240:243], v[196:199], v[76:79], v[240:243]
    ds_read_b128 v[176:179], v16 offset:4096
    v_mfma_f32_16x16x32_bf16 v[240:243], v[192:195], v[80:83], v[240:243]
    ds_read2_b32 v[112:113], v12 offset0:32 offset1:33
    v_mfma_f32_16x16x32_bf16 v[244:247], v[212:215], v[64:67], v[244:247]
    ds_read2_b32 v[114:115], v12 offset0:34 offset1:35
    v_mfma_f32_16x16x32_bf16 v[244:247], v[208:211], v[68:71], v[244:247]
    ds_read_b128 v[180:183], v16 offset:5120
    v_mfma_f32_16x16x32_bf16 v[244:247], v[204:207], v[72:75], v[244:247]
    ds_read2_b32 v[116:117], v12 offset0:160 offset1:161
    v_mfma_f32_16x16x32_bf16 v[244:247], v[200:203], v[76:79], v[244:247]
    ds_read2_b32 v[118:119], v12 offset0:162 offset1:163
    v_mfma_f32_16x16x32_bf16 v[244:247], v[196:199], v[80:83], v[244:247]
    ds_read_b128 v[184:187], v16 offset:6144
    v_mfma_f32_16x16x32_bf16 v[244:247], v[192:195], v[84:87], v[244:247]
    ds_read2_b32 v[120:121], v13 offset0:32 offset1:33
    v_mfma_f32_16x16x32_bf16 v[248:251], v[216:219], v[64:67], v[248:251]
    ds_read2_b32 v[122:123], v13 offset0:34 offset1:35
    v_mfma_f32_16x16x32_bf16 v[248:251], v[212:215], v[68:71], v[248:251]
    ds_read_b128 v[188:191], v16 offset:7168
    v_mfma_f32_16x16x32_bf16 v[248:251], v[208:211], v[72:75], v[248:251]
    ds_read2_b32 v[124:125], v13 offset0:160 offset1:161
    v_mfma_f32_16x16x32_bf16 v[248:251], v[204:207], v[76:79], v[248:251]
    ds_read2_b32 v[126:127], v13 offset0:162 offset1:163
    v_mfma_f32_16x16x32_bf16 v[248:251], v[200:203], v[80:83], v[248:251]
    v_mfma_f32_16x16x32_bf16 v[248:251], v[196:199], v[84:87], v[248:251]
    v_mfma_f32_16x16x32_bf16 v[248:251], v[192:195], v[88:91], v[248:251]
    v_mfma_f32_16x16x32_bf16 v[252:255], v[220:223], v[64:67], v[252:255]
    v_mfma_f32_16x16x32_bf16 v[252:255], v[216:219], v[68:71], v[252:255]
    v_mfma_f32_16x16x32_bf16 v[252:255], v[212:215], v[72:75], v[252:255]
    v_mfma_f32_16x16x32_bf16 v[252:255], v[208:211], v[76:79], v[252:255]
    v_mfma_f32_16x16x32_bf16 v[252:255], v[204:207], v[80:83], v[252:255]
    v_mfma_f32_16x16x32_bf16 v[252:255], v[200:203], v[84:87], v[252:255]
    v_mfma_f32_16x16x32_bf16 v[252:255], v[196:199], v[88:91], v[252:255]
    v_mfma_f32_16x16x32_bf16 v[252:255], v[192:195], v[92:95], v[252:255]
    s_waitcnt lgkmcnt(0)
    s_nop 0
    v_mfma_f32_16x16x32_bf16 v[224:227], v[160:163], v[96:99], v[224:227]
    v_mfma_f32_16x16x32_bf16 v[228:231], v[164:167], v[96:99], v[228:231]
    ds_read_b128 v[192:195], v17 offset:0
    v_mfma_f32_16x16x32_bf16 v[228:231], v[160:163], v[100:103], v[228:231]
    ds_read2_b32 v[128:129], v10 offset0:36 offset1:37
    v_mfma_f32_16x16x32_bf16 v[232:235], v[168:171], v[96:99], v[232:235]
    ds_read2_b32 v[130:131], v10 offset0:38 offset1:39
    v_mfma_f32_16x16x32_bf16 v[232:235], v[164:167], v[100:103], v[232:235]
    ds_read_b128 v[196:199], v17 offset:1024
    v_mfma_f32_16x16x32_bf16 v[232:235], v[160:163], v[104:107], v[232:235]
    ds_read2_b32 v[132:133], v10 offset0:164 offset1:165
    v_mfma_f32_16x16x32_bf16 v[236:239], v[172:175], v[96:99], v[236:239]
    ds_read2_b32 v[134:135], v10 offset0:166 offset1:167
    v_mfma_f32_16x16x32_bf16 v[236:239], v[168:171], v[100:103], v[236:239]
    ds_read_b128 v[200:203], v17 offset:2048
    v_mfma_f32_16x16x32_bf16 v[236:239], v[164:167], v[104:107], v[236:239]
    ds_read2_b32 v[136:137], v11 offset0:36 offset1:37
    v_mfma_f32_16x16x32_bf16 v[236:239], v[160:163], v[108:111], v[236:239]
    ds_read2_b32 v[138:139], v11 offset0:38 offset1:39
    v_mfma_f32_16x16x32_bf16 v[240:243], v[176:179], v[96:99], v[240:243]
    ds_read_b128 v[204:207], v17 offset:3072
    v_mfma_f32_16x16x32_bf16 v[240:243], v[172:175], v[100:103], v[240:243]
    ds_read2_b32 v[140:141], v11 offset0:164 offset1:165
    v_mfma_f32_16x16x32_bf16 v[240:243], v[168:171], v[104:107], v[240:243]
    ds_read2_b32 v[142:143], v11 offset0:166 offset1:167
    v_mfma_f32_16x16x32_bf16 v[240:243], v[164:167], v[108:111], v[240:243]
    ds_read_b128 v[208:211], v17 offset:4096
    v_mfma_f32_16x16x32_bf16 v[240:243], v[160:163], v[112:115], v[240:243]
    ds_read2_b32 v[144:145], v12 offset0:36 offset1:37
    v_mfma_f32_16x16x32_bf16 v[244:247], v[180:183], v[96:99], v[244:247]
    ds_read2_b32 v[146:147], v12 offset0:38 offset1:39
    v_mfma_f32_16x16x32_bf16 v[244:247], v[176:179], v[100:103], v[244:247]
    ds_read_b128 v[212:215], v17 offset:5120
    v_mfma_f32_16x16x32_bf16 v[244:247], v[172:175], v[104:107], v[244:247]
    ds_read2_b32 v[148:149], v12 offset0:164 offset1:165
    v_mfma_f32_16x16x32_bf16 v[244:247], v[168:171], v[108:111], v[244:247]
    ds_read2_b32 v[150:151], v12 offset0:166 offset1:167
    v_mfma_f32_16x16x32_bf16 v[244:247], v[164:167], v[112:115], v[244:247]
    ds_read_b128 v[216:219], v17 offset:6144
    v_mfma_f32_16x16x32_bf16 v[244:247], v[160:163], v[116:119], v[244:247]
    ds_read2_b32 v[152:153], v13 offset0:36 offset1:37
    v_mfma_f32_16x16x32_bf16 v[248:251], v[184:187], v[96:99], v[248:251]
    ds_read2_b32 v[154:155], v13 offset0:38 offset1:39
    v_mfma_f32_16x16x32_bf16 v[248:251], v[180:183], v[100:103], v[248:251]
    ds_read_b128 v[220:223], v17 offset:7168
    v_mfma_f32_16x16x32_bf16 v[248:251], v[176:179], v[104:107], v[248:251]
    ds_read2_b32 v[156:157], v13 offset0:164 offset1:165
    v_mfma_f32_16x16x32_bf16 v[248:251], v[172:175], v[108:111], v[248:251]
    ds_read2_b32 v[158:159], v13 offset0:166 offset1:167
    v_mfma_f32_16x16x32_bf16 v[248:251], v[168:171], v[112:115], v[248:251]
    v_mfma_f32_16x16x32_bf16 v[248:251], v[164:167], v[116:119], v[248:251]
    v_mfma_f32_16x16x32_bf16 v[248:251], v[160:163], v[120:123], v[248:251]
    v_mfma_f32_16x16x32_bf16 v[252:255], v[188:191], v[96:99], v[252:255]
    v_mfma_f32_16x16x32_bf16 v[252:255], v[184:187], v[100:103], v[252:255]
    v_mfma_f32_16x16x32_bf16 v[252:255], v[180:183], v[104:107], v[252:255]
    v_mfma_f32_16x16x32_bf16 v[252:255], v[176:179], v[108:111], v[252:255]
    v_mfma_f32_16x16x32_bf16 v[252:255], v[172:175], v[112:115], v[252:255]
    v_mfma_f32_16x16x32_bf16 v[252:255], v[168:171], v[116:119], v[252:255]
    v_mfma_f32_16x16x32_bf16 v[252:255], v[164:167], v[120:123], v[252:255]
    v_mfma_f32_16x16x32_bf16 v[252:255], v[160:163], v[124:127], v[252:255]
    s_waitcnt lgkmcnt(0)
    s_nop 0
    v_mfma_f32_16x16x32_bf16 v[224:227], v[192:195], v[128:131], v[224:227]
    v_mfma_f32_16x16x32_bf16 v[228:231], v[196:199], v[128:131], v[228:231]
    v_mfma_f32_16x16x32_bf16 v[228:231], v[192:195], v[132:135], v[228:231]
    v_mfma_f32_16x16x32_bf16 v[232:235], v[200:203], v[128:131], v[232:235]
    v_mfma_f32_16x16x32_bf16 v[232:235], v[196:199], v[132:135], v[232:235]
    v_mfma_f32_16x16x32_bf16 v[232:235], v[192:195], v[136:139], v[232:235]
    v_mfma_f32_16x16x32_bf16 v[236:239], v[204:207], v[128:131], v[236:239]
    v_mfma_f32_16x16x32_bf16 v[236:239], v[200:203], v[132:135], v[236:239]
    v_mfma_f32_16x16x32_bf16 v[236:239], v[196:199], v[136:139], v[236:239]
    ds_write_b128 v2, v[224:227] offset:25856
    v_mfma_f32_16x16x32_bf16 v[236:239], v[192:195], v[140:143], v[236:239]
    v_mfma_f32_16x16x32_bf16 v[240:243], v[208:211], v[128:131], v[240:243]
    ds_write_b128 v2, v[228:231] offset:26944
    v_mfma_f32_16x16x32_bf16 v[240:243], v[204:207], v[132:135], v[240:243]
    v_mfma_f32_16x16x32_bf16 v[240:243], v[200:203], v[136:139], v[240:243]
    v_mfma_f32_16x16x32_bf16 v[240:243], v[196:199], v[140:143], v[240:243]
    ds_write_b128 v2, v[232:235] offset:28032
    v_mfma_f32_16x16x32_bf16 v[240:243], v[192:195], v[144:147], v[240:243]
    v_mfma_f32_16x16x32_bf16 v[244:247], v[212:215], v[128:131], v[244:247]
    v_mfma_f32_16x16x32_bf16 v[244:247], v[208:211], v[132:135], v[244:247]
    v_mfma_f32_16x16x32_bf16 v[244:247], v[204:207], v[136:139], v[244:247]
    ds_write_b128 v2, v[236:239] offset:29120
    v_mfma_f32_16x16x32_bf16 v[244:247], v[200:203], v[140:143], v[244:247]
    v_mfma_f32_16x16x32_bf16 v[244:247], v[196:199], v[144:147], v[244:247]
    v_mfma_f32_16x16x32_bf16 v[244:247], v[192:195], v[148:151], v[244:247]
    v_mfma_f32_16x16x32_bf16 v[248:251], v[216:219], v[128:131], v[248:251]
    v_mfma_f32_16x16x32_bf16 v[248:251], v[212:215], v[132:135], v[248:251]
    ds_write_b128 v2, v[240:243] offset:30208
    v_mfma_f32_16x16x32_bf16 v[248:251], v[208:211], v[136:139], v[248:251]
    v_mfma_f32_16x16x32_bf16 v[248:251], v[204:207], v[140:143], v[248:251]
    v_mfma_f32_16x16x32_bf16 v[248:251], v[200:203], v[144:147], v[248:251]
    v_mfma_f32_16x16x32_bf16 v[248:251], v[196:199], v[148:151], v[248:251]
    v_mfma_f32_16x16x32_bf16 v[248:251], v[192:195], v[152:155], v[248:251]
    global_load_dword v31, v30, s[58:59] offset:1024 sc1
    v_mfma_f32_16x16x32_bf16 v[252:255], v[220:223], v[128:131], v[252:255]
    ds_write_b128 v2, v[244:247] offset:31296
    v_mfma_f32_16x16x32_bf16 v[252:255], v[216:219], v[132:135], v[252:255]
    v_mfma_f32_16x16x32_bf16 v[252:255], v[212:215], v[136:139], v[252:255]
    v_mfma_f32_16x16x32_bf16 v[252:255], v[208:211], v[140:143], v[252:255]
    v_mfma_f32_16x16x32_bf16 v[252:255], v[204:207], v[144:147], v[252:255]
    v_mfma_f32_16x16x32_bf16 v[252:255], v[200:203], v[148:151], v[252:255]
    v_mfma_f32_16x16x32_bf16 v[252:255], v[196:199], v[152:155], v[252:255]
    v_mfma_f32_16x16x32_bf16 v[252:255], v[192:195], v[156:159], v[252:255]
    ds_write_b128 v2, v[248:251] offset:32384
    s_nop 6
    ds_write_b128 v2, v[252:255] offset:33472
    ds_write_b8 v5, v4 offset:4
L_a_rw:
    ds_read_b32 v28, v26 offset:4
    s_waitcnt lgkmcnt(0)
    v_cmp_ne_u32 vcc, 0x01010101, v28
    s_cbranch_vccnz L_a_rw
    s_nop 0
    ds_read_b128 v[32:35], v3 offset:25856
    ds_read_b128 v[36:39], v3 offset:34560
    ds_read_b128 v[40:43], v3 offset:43264
    ds_read_b128 v[44:47], v3 offset:51968
    ds_read_b128 v[48:51], v3 offset:25888
    ds_read_b128 v[52:55], v3 offset:34592
    ds_read_b128 v[56:59], v3 offset:43296
    ds_read_b128 v[60:63], v3 offset:52000
    s_cmp_eq_u32 s96, 1
    s_cbranch_scc1 L_a_yfar
    s_waitcnt lgkmcnt(4)
    v_add_f32 v32, v32, v36
    v_add_f32 v33, v33, v37
    v_add_f32 v34, v34, v38
    v_add_f32 v35, v35, v39
    v_add_f32 v40, v40, v44
    v_add_f32 v41, v41, v45
    v_add_f32 v42, v42, v46
    v_add_f32 v43, v43, v47
    v_cvt_pk_bf16_f32 v64, v32, v40
    v_cvt_pk_bf16_f32 v65, v33, v41
    v_cvt_pk_bf16_f32 v66, v34, v42
    v_cvt_pk_bf16_f32 v67, v35, v43
    s_waitcnt vmcnt(0)
    v_cmp_ne_u32 vcc, v9, v31
    s_cbranch_vccnz L_a_ww
L_a_wok:
    global_store_dwordx4 v19, v[64:67], s[16:17] offset:0
    s_waitcnt lgkmcnt(0)
    v_add_f32 v48, v48, v52
    v_add_f32 v49, v49, v53
    v_add_f32 v50, v50, v54
    v_add_f32 v51, v51, v55
    v_add_f32 v56, v56, v60
    v_add_f32 v57, v57, v61
    v_add_f32 v58, v58, v62
    v_add_f32_e64 v59, v59, v63
    v_cvt_pk_bf16_f32 v68, v48, v56
    v_cvt_pk_bf16_f32 v69, v49, v57
    v_cvt_pk_bf16_f32 v70, v50, v58
    v_cvt_pk_bf16_f32 v71, v51, v59
    global_store_dwordx4 v19, v[68:71], s[16:17] offset:2048
    s_mov_b64 exec, 1
    s_waitcnt vmcnt(0)
    global_store_dword v29, v9, s[58:59] offset:512
L_a_done:
    s_endpgm
L_roleB:
    v_lshlrev_b32 v243, 4, v1
    v_bfe_u32 v161, v0, 5, 1
    v_cvt_f32_u32 v161, v161
    v_and_b32 v167, 1, v0
    s_mov_b32 s62, 0x80008000
    s_cmp_ge_u32 s6, 2
    s_cbranch_scc1 L_b_c23
    v_and_b32 v160, 24, v0
    v_and_b32 v162, 3, v0
    v_lshl_add_u32 v160, v162, 1, v160
    v_bfe_u32 v162, v0, 2, 1
    v_add_u32 v160, v160, v162
    v_cvt_f32_u32 v160, v160
    s_cmp_eq_u32 s6, 1
    s_cbranch_scc1 L_b_c1
    v_mul_lo_u32 v165, v162, s62
    v_mul_f32 v163, 0x3d000000, v160
    v_mul_f32 v164, 0x41000000, v161
    v_mul_f32 v164, v164, v163
    v_cos_f32 v128, v164
    v_sin_f32 v136, v164
    v_add_f32 v164, v164, v163
    v_cos_f32 v129, v164
    v_sin_f32 v137, v164
    v_add_f32 v164, v164, v163
    v_cos_f32 v130, v164
    v_sin_f32 v138, v164
    v_add_f32 v164, v164, v163
    v_cos_f32 v131, v164
    v_sin_f32 v139, v164
    v_add_f32 v164, v164, v163
    v_cos_f32 v132, v164
    v_sin_f32 v140, v164
    v_add_f32 v164, v164, v163
    v_cos_f32 v133, v164
    v_sin_f32 v141, v164
    v_add_f32 v164, v164, v163
    v_cos_f32 v134, v164
    v_sin_f32 v142, v164
    v_add_f32 v164, v164, v163
    v_cos_f32 v135, v164
    v_sin_f32 v143, v164
    v_cvt_pk_bf16_f32 v8, v128, v129
    v_cvt_pk_bf16_f32 v16, v136, v137
    v_cvt_pk_bf16_f32 v9, v130, v131
    v_cvt_pk_bf16_f32 v17, v138, v139
    v_cvt_pk_bf16_f32 v10, v132, v133
    v_cvt_pk_bf16_f32 v18, v140, v141
    v_cvt_pk_bf16_f32 v11, v134, v135
    v_cvt_pk_bf16_f32 v19, v142, v143
    v_xor_b32 v12, v165, v8
    v_xor_b32 v20, v165, v16
    v_xor_b32 v24, s62, v16
    v_xor_b32 v28, s62, v20
    v_xor_b32 v13, v165, v9
    v_xor_b32 v21, v165, v17
    v_xor_b32 v25, s62, v17
    v_xor_b32 v29, s62, v21
    v_xor_b32 v14, v165, v10
    v_xor_b32 v22, v165, v18
    v_xor_b32 v26, s62, v18
    v_xor_b32 v30, s62, v22
    v_xor_b32 v15, v165, v11
    v_xor_b32 v23, v165, v19
    v_xor_b32 v27, s62, v19
    v_xor_b32 v31, s62, v23
    ds_write_b128 v243, v[8:11] offset:35072
    ds_write_b128 v243, v[12:15] offset:36096
    ds_write_b128 v243, v[16:19] offset:37120
    ds_write_b128 v243, v[20:23] offset:38144
    ds_write_b128 v243, v[24:27] offset:39168
    ds_write_b128 v243, v[28:31] offset:40192
    s_branch L_b_cd
L_b_c1:
    v_mul_f32 v163, 0x3b000000, v160
    v_mul_f32 v166, 4.0, v161
    v_mul_f32 v164, v166, v163
    v_cos_f32 v32, v164
    v_sin_f32 v40, v164
    v_add_f32 v164, v164, v163
    v_cos_f32 v33, v164
    v_sin_f32 v41, v164
    v_add_f32 v164, v164, v163
    v_cos_f32 v34, v164
    v_sin_f32 v42, v164
    v_add_f32 v164, v164, v163
    v_cos_f32 v35, v164
    v_sin_f32 v43, v164
    v_fmamk_f32 v164, v163, 0x40a00000, v164
    v_cos_f32 v36, v164
    v_sin_f32 v44, v164
    v_add_f32 v164, v164, v163
    v_cos_f32 v37, v164
    v_sin_f32 v45, v164
    v_add_f32 v164, v164, v163
    v_cos_f32 v38, v164
    v_sin_f32 v46, v164
    v_add_f32 v164, v164, v163
    v_cos_f32 v39, v164
    v_sin_f32 v47, v164
    s_nop 0
    ds_write_b128 v243, v[32:35] offset:41216
    ds_write_b128 v243, v[36:39] offset:42240
    ds_write_b128 v243, v[40:43] offset:43264
    ds_write_b128 v243, v[44:47] offset:44288
    s_branch L_b_cd
L_b_c23:
    v_cvt_f32_u32 v162, v167
    v_mul_f32 v162, 0.25, v162
    s_cmp_eq_u32 s6, 3
    s_cbranch_scc1 L_b_c3
    s_cmp_eq_u32 s40, 0
    s_cselect_b32 s3, 0, 1.0
    v_mul_f32 v162, s3, v162
    v_mul_lo_u32 v165, v167, s62
    v_mul_f32 v166, 4.0, v161
    v_bfe_u32 v160, v0, 1, 4
    v_cvt_f32_u32 v160, v160
    v_mul_f32 v163, 0x3d800000, v160
    v_fma_f32 v164, v166, v163, v162
    v_cos_f32 v128, v164
    v_sin_f32 v136, v164
    v_add_f32 v164, v164, v163
    v_cos_f32 v129, v164
    v_sin_f32 v137, v164
    v_add_f32 v164, v164, v163
    v_cos_f32 v130, v164
    v_sin_f32 v138, v164
    v_add_f32 v164, v164, v163
    v_cos_f32 v131, v164
    v_sin_f32 v139, v164
    v_fmamk_f32 v164, v163, 0x40a00000, v164
    v_cos_f32 v132, v164
    v_sin_f32 v140, v164
    v_add_f32 v164, v164, v163
    v_cos_f32 v133, v164
    v_sin_f32 v141, v164
    v_add_f32 v164, v164, v163
    v_cos_f32 v134, v164
    v_sin_f32 v142, v164
    v_add_f32 v164, v164, v163
    v_cos_f32 v135, v164
    v_sin_f32_e64 v143, v164
    v_cvt_pk_bf16_f32 v48, v128, v129
    v_cvt_pk_bf16_f32 v52, v136, v137
    v_cvt_pk_bf16_f32 v49, v130, v131
    v_cvt_pk_bf16_f32 v53, v138, v139
    v_cvt_pk_bf16_f32 v50, v132, v133
    v_cvt_pk_bf16_f32 v54, v140, v141
    v_cvt_pk_bf16_f32 v51, v134, v135
    v_cvt_pk_bf16_f32 v55, v142, v143
    s_cbranch_scc1 L_b_s0
    v_xor_b32 v56, v165, v48
    v_xor_b32 v57, v165, v49
    v_xor_b32 v58, v165, v50
    v_xor_b32 v59, v165, v51
    v_xor_b32 v60, v165, v52
    v_xor_b32 v61, v165, v53
    v_xor_b32 v62, v165, v54
    v_xor_b32 v63, v165, v55
L_b_s0back:
    ds_write_b128 v243, v[48:51] offset:45312
    ds_write_b128 v243, v[52:55] offset:46336
    ds_write_b128 v243, v[56:59] offset:47360
    ds_write_b128 v243, v[60:63] offset:48384
    s_branch L_b_cd
L_b_c3:
    v_bfe_u32 v160, v0, 1, 2
    s_lshl_b32 s3, s7, 2
    v_add_u32 v160, s3, v160
    v_cvt_f32_u32 v160, v160
    v_cvt_f32_u32 v161, v241
    v_mul_f32 v163, 0x3a000000, v160
    v_fma_f32 v165, v163, v161, v162
    v_mul_f32 v166, 0x35000000, v160
    v_cvt_f32_u32 v164, s48
    v_fma_f32 v164, v164, v166, v165
    v_cos_f32 v168, v164
    v_cvt_f32_u32 v164, s49
    v_fma_f32 v164, v164, v166, v165
    v_cos_f32 v169, v164
    v_cvt_f32_u32 v164, s50
    v_fma_f32 v164, v164, v166, v165
    v_cos_f32 v170, v164
    v_cvt_f32_u32 v164, s51
    v_fma_f32 v164, v164, v166, v165
    v_cos_f32 v171, v164
    v_cvt_pk_bf16_f32 v4, v168, v169
    v_cvt_pk_bf16_f32 v5, v170, v171
    s_mov_b32 exec_lo, 0xff00ff00
    s_mov_b32 exec_hi, 0x00ff00ff
    v_mov_b64 v[4:5], 0
    s_mov_b64 exec, -1
    ds_write_b128 v243, v[4:7] offset:34048
L_b_cd:
    ds_write_b8 v244, v245 offset:12
    v_lshrrev_b32 v232, 4, v1
    v_and_b32 v233, 15, v0
    v_and_b32 v237, 7, v0
    v_mul_u32_u24 v2, 2064, v237
    v_and_b32 v3, 8, v0
    v_lshl_add_u32 v2, v3, 7, v2
    v_lshl_add_u32 v2, v242, 3, v2
    v_bfe_u32 v3, v0, 5, 1
    v_lshl_add_u32 v2, v3, 3, v2
    v_add_u32 v2, s41, v2
    v_lshlrev_b32 v3, 8, v3
    v_lshl_add_u32 v3, v242, 6, v3
    v_lshl_add_u32 v3, v233, 4, v3
    s_mul_i32 s3, s6, 4128
    v_add_u32 v3, s3, v3
    s_mov_b32 s46, 0x05040100
    s_mov_b32 s47, 0x07060302
L_b_cw:
    ds_read_b32 v247, v246 offset:12
    s_waitcnt lgkmcnt(0)
    v_cmp_ne_u32 vcc, 0x01010101, v247
    s_cbranch_vccnz L_b_cw
    s_nop 0
    ds_read_b128 v[4:7], v243 offset:34048
    ds_read_b128 v[8:11], v243 offset:35072
    ds_read_b128 v[12:15], v243 offset:36096
    ds_read_b128 v[16:19], v243 offset:37120
    ds_read_b128 v[20:23], v243 offset:38144
    ds_read_b128 v[24:27], v243 offset:39168
    ds_read_b128 v[28:31], v243 offset:40192
    ds_read_b128 v[32:35], v243 offset:41216
    ds_read_b128 v[36:39], v243 offset:42240
    ds_read_b128 v[40:43], v243 offset:43264
    ds_read_b128 v[44:47], v243 offset:44288
    ds_read_b128 v[48:51], v243 offset:45312
    ds_read_b128 v[52:55], v243 offset:46336
    ds_read_b128 v[56:59], v243 offset:47360
    ds_read_b128 v[60:63], v243 offset:48384
    s_waitcnt vmcnt(0)
    v_lshlrev_b32 v128, 16, v224
    v_and_b32 v129, 0xffff0000, v224
    v_lshlrev_b32 v130, 16, v225
    v_and_b32 v131, 0xffff0000, v225
    v_lshlrev_b32 v132, 16, v226
    v_and_b32 v133, 0xffff0000, v226
    v_lshlrev_b32 v134, 16, v227
    v_and_b32 v135, 0xffff0000, v227
    v_lshlrev_b32 v136, 16, v228
    v_and_b32 v137, 0xffff0000, v228
    v_lshlrev_b32 v138, 16, v229
    v_and_b32 v139, 0xffff0000, v229
    v_lshlrev_b32 v140, 16, v230
    v_and_b32 v141, 0xffff0000, v230
    v_lshlrev_b32 v142, 16, v231
    v_and_b32 v143, 0xffff0000, v231
    v_lshlrev_b32 v144, 16, v220
    v_and_b32 v145, 0xffff0000, v220
    v_lshlrev_b32 v146, 16, v221
    v_and_b32 v147, 0xffff0000, v221
    v_lshlrev_b32 v148, 16, v222
    v_and_b32 v149, 0xffff0000, v222
    v_lshlrev_b32_e64 v150, 16, v223
    v_and_b32 v151, 0xffff0000, v223
    v_pk_mul_f32 v[128:129], v[128:129], v[144:145]
    v_pk_mul_f32 v[130:131], v[130:131], v[146:147]
    v_pk_mul_f32 v[132:133], v[132:133], v[148:149]
    v_pk_mul_f32 v[134:135], v[134:135], v[150:151]
    v_pk_mul_f32 v[136:137], v[136:137], v[144:145]
    v_pk_mul_f32 v[138:139], v[138:139], v[146:147]
    v_pk_mul_f32 v[140:141], v[140:141], v[148:149]
    v_pk_mul_f32 v[142:143], v[142:143], v[150:151]
    v_cvt_pk_bf16_f32 v128, 0, v128
    v_cvt_pk_bf16_f32 v129, 0, v129
    v_cvt_pk_bf16_f32 v130, 0, v130
    v_cvt_pk_bf16_f32 v131, 0, v131
    v_cvt_pk_bf16_f32 v132, 0, v132
    v_cvt_pk_bf16_f32 v133, 0, v133
    v_cvt_pk_bf16_f32 v134, 0, v134
    v_cvt_pk_bf16_f32 v135, 0, v135
    v_cvt_pk_bf16_f32 v136, 0, v136
    v_cvt_pk_bf16_f32 v137, 0, v137
    v_cvt_pk_bf16_f32 v138, 0, v138
    v_cvt_pk_bf16_f32 v139, 0, v139
    v_cvt_pk_bf16_f32 v140, 0, v140
    v_cvt_pk_bf16_f32 v141, 0, v141
    v_cvt_pk_bf16_f32 v142, 0, v142
    v_cvt_pk_bf16_f32 v143, 0, v143
    v_pk_add_f32 v[128:129], v[128:129], v[130:131]
    v_pk_add_f32 v[132:133], v[132:133], v[134:135]
    v_pk_add_f32 v[136:137], v[136:137], v[138:139]
    v_pk_add_f32 v[140:141], v[140:141], v[142:143]
    v_pk_add_f32 v[128:129], v[128:129], v[132:133]
    v_pk_add_f32 v[136:137], v[136:137], v[140:141]
    v_add_f32 v144, v128, v129
    v_add_f32 v145, v136, v137
    v_perm_b32 v96, v228, v224, s46
    v_perm_b32 v98, v228, v224, s47
    v_add_f32_dpp v144, v144, v144 row_ror:8 row_mask:0xf bank_mask:0xf
    v_add_f32_dpp v145, v145, v145 row_ror:8 row_mask:0xf bank_mask:0xf
    v_perm_b32 v100, v229, v225, s46
    v_perm_b32 v102, v229, v225, s47
    v_add_f32_dpp v144, v144, v144 row_ror:4 row_mask:0xf bank_mask:0xf
    v_add_f32_dpp v145, v145, v145 row_ror:4 row_mask:0xf bank_mask:0xf
    v_perm_b32 v104, v230, v226, s46
    v_perm_b32 v106, v230, v226, s47
    v_add_f32_dpp v144, v144, v144 row_ror:2 row_mask:0xf bank_mask:0xf
    v_add_f32_dpp v145, v145, v145 row_ror:2 row_mask:0xf bank_mask:0xf
    v_perm_b32 v108, v231, v227, s46
    v_perm_b32 v110, v231, v227, s47
    v_add_f32_dpp v144, v144, v144 row_ror:1 row_mask:0xf bank_mask:0xf
    v_add_f32_dpp v145, v145, v145 row_ror:1 row_mask:0xf bank_mask:0xf
    s_lshl_b32 s3, s6, 2
    v_lshl_add_u32 v146, v232, 5, s3
    v_lshlrev_b32 v255, 4, v237
    ds_write_b32 v146, v144 offset:50432
    ds_write_b32 v146, v145 offset:50448
    s_waitcnt lgkmcnt(2)
    s_nop 0
    v_perm_b32 v97, v76, v72, s46
    v_perm_b32 v99, v76, v72, s47
    v_perm_b32 v101, v77, v73, s46
    v_mfma_f32_16x16x16_bf16 v[128:131], v[96:97], v[4:5], 0
    v_perm_b32 v103, v77, v73, s47
    v_perm_b32 v105, v78, v74, s46
    v_mfma_f32_16x16x16_bf16 v[132:135], v[98:99], v[4:5], 0
    v_perm_b32 v107, v78, v74, s47
    v_perm_b32 v109, v79, v75, s46
    v_mfma_f32_16x16x16_bf16 v[136:139], v[100:101], v[4:5], 0
    v_perm_b32 v111, v79, v75, s47
    v_mfma_f32_16x16x16_bf16 v[140:143], v[102:103], v[4:5], 0
    v_mfma_f32_16x16x16_bf16 v[144:147], v[104:105], v[4:5], 0
    v_cvt_pk_bf16_f32 v160, v128, v129
    v_cvt_pk_bf16_f32 v161, v130, v131
    ds_write_b64 v2, v[160:161] offset:60672
    v_mfma_f32_16x16x16_bf16 v[148:151], v[106:107], v[4:5], 0
    v_cvt_pk_bf16_f32 v162, v132, v133
    v_cvt_pk_bf16_f32 v163, v134, v135
    ds_write_b64 v2, v[162:163] offset:60688
    v_mfma_f32_16x16x16_bf16 v[152:155], v[108:109], v[4:5], 0
    v_cvt_pk_bf16_f32 v164, v136, v137
    v_cvt_pk_bf16_f32 v165, v138, v139
    ds_write_b64 v2, v[164:165] offset:60704
    v_mfma_f32_16x16x16_bf16 v[156:159], v[110:111], v[4:5], 0
    v_cvt_pk_bf16_f32 v166, v140, v141
    v_cvt_pk_bf16_f32 v167, v142, v143
    ds_write_b64 v2, v[166:167] offset:60720
    v_cvt_pk_bf16_f32 v168, v144, v145
    v_cvt_pk_bf16_f32 v169, v146, v147
    ds_write_b64 v2, v[168:169] offset:60736
    v_cvt_pk_bf16_f32 v170, v148, v149
    v_cvt_pk_bf16_f32 v171, v150, v151
    ds_write_b64 v2, v[170:171] offset:60752
    v_cvt_pk_bf16_f32 v172, v152, v153
    v_cvt_pk_bf16_f32 v173, v154, v155
    ds_write_b64 v2, v[172:173] offset:60768
    v_cvt_pk_bf16_f32 v174, v156, v157
    v_cvt_pk_bf16_f32 v175, v158, v159
    ds_write_b64 v2, v[174:175] offset:60784
    ds_write_b8 v244, v245 offset:24
L_b_xw:
    ds_read_b32 v247, v246 offset:24
    s_waitcnt lgkmcnt(0)
    v_cmp_ne_u32 vcc, 0x01010101, v247
    s_cbranch_vccnz L_b_xw
    ds_read_b128 v[64:67], v3 offset:60672
    ds_read_b128 v[68:71], v3 offset:61184
    ds_read_b128 v[72:75], v3 offset:62736
    ds_read_b128 v[76:79], v3 offset:63248
    ds_read_b128 v[252:255], v255 offset:50432
    v_and_b32 v160, 28, v0
    v_lshlrev_b32 v238, 6, v160
    v_and_b32 v161, 3, v0
    v_lshl_add_u32 v238, v161, 4, v238
    v_and_b32 v161, 32, v0
    v_lshl_add_u32 v238, v161, 1, v238
    s_and_b32 s3, s40, 4
    s_lshl_b32 s3, s3, 4
    v_xor_b32 v238, s3, v238
    v_add_u32 v219, v160, v161
    s_lshl2_add_u32 s3, s6, 50688
    v_lshl_add_u32 v219, v219, 3, s3
    s_lshl2_add_u32 s3, s7, s6
    s_lshl_b32 s3, s3, 7
    s_add_u32 s43, s3, s40
    s_mul_i32 s3, s43, 2048
    s_add_u32 s3, s3, 4194304
    s_add_u32 s28, s38, s3
    s_addc_u32 s29, s39, 0
    s_waitcnt lgkmcnt(4)
    v_mfma_f32_32x32x16_bf16 v[96:111], v[64:67], v[8:11], 0
    s_mov_b64 s[12:13], s[34:35]
    s_mov_b32 s14, 0x200000
    s_mov_b32 s15, 0x20000
    v_and_b32 v92, 58, v0
    v_lshlrev_b32 v88, 4, v92
    v_and_b32 v92, 20, v0
    v_lshl_add_u32 v88, v92, 2, v88
    v_and_b32 v92, 1, v0
    v_lshl_add_u32 v88, v92, 3, v88
    s_waitcnt lgkmcnt(3)
    v_mfma_f32_32x32x16_bf16 v[96:111], v[68:71], v[12:15], v[96:111]
    v_add_u32 v88, 60672, v88
    v_xor_b32 v89, 64, v88
    v_and_b32 v92, 0xfc, v0
    v_lshlrev_b32 v92, 12, v92
    v_and_b32 v93, 2, v232
    v_xor_b32 v93, v93, v0
    v_and_b32 v93, 3, v93
    v_lshl_add_u32 v92, v93, 4, v92
    s_and_b32 s24, s5, 15
    s_waitcnt lgkmcnt(2)
    v_mfma_f32_32x32x16_bf16 v[96:111], v[72:75], v[16:19], v[96:111]
    s_lshl3_add_u32 s24, s24, s4
    s_lshl1_add_u32 s24, s24, s7
    s_lshl_b32 s24, s24, 6
    s_add_u32 s52, s34, s24
    s_addc_u32 s53, s35, 0
    s_add_u32 s54, s52, 0xffc00
    s_addc_u32 s55, s53, 0
    v_bfe_u32 v93, v0, 2, 2
    v_and_b32 v93, 2, v93
    s_waitcnt lgkmcnt(1)
    v_mfma_f32_32x32x16_bf16 v[96:111], v[76:79], v[20:23], v[96:111]
    v_xor_b32 v93, v93, v232
    v_lshlrev_b32 v93, 4, v93
    v_lshl_add_u32 v93, v233, 6, v93
    s_lshl_b32 s41, s6, 11
    v_add_u32 v93, s41, v93
    s_bfe_u32 s3, s5, 0x20002
    s_lshl1_add_u32 s3, s3, s7
    s_lshl_b32 s3, s3, 6
    v_lshl_add_u32 v94, v233, 2, s3
    v_mfma_f32_32x32x16_bf16 v[112:127], v[64:67], v[24:27], 0
    s_waitcnt lgkmcnt(0)
    v_add_f32 v252, v252, v254
    v_add_f32 v253, v253, v255
    v_add_f32 v252, v252, v253
    v_cvt_pk_bf16_f32 v252, 0, v252
    v_mul_f32 v252, 0xbfb8aa3b, v252
    v_exp_f32 v252, v252
    s_nop 0
    v_add_f32 v252, 1.0, v252
    v_rcp_f32 v252, v252
    s_nop 0
    v_cvt_pk_bf16_f32 v252, 0, v252
    v_sub_f32 v254, 1.0, v252
    v_cvt_pk_bf16_f32 v252, v254, v252
    v_mfma_f32_32x32x16_bf16 v[112:127], v[68:71], v[28:31], v[112:127]
    v_mul_f32 v128, v96, v32
    v_mul_f32_e64 v144, -v96, v40
    v_mul_f32 v129, v97, v33
    v_mul_f32_e64 v145, -v97, v41
    v_mul_f32 v130, v98, v34
    v_mul_f32_e64 v146, -v98, v42
    v_mfma_f32_32x32x16_bf16 v[112:127], v[72:75], v[8:11], v[112:127]
    v_mul_f32 v131, v99, v35
    v_mul_f32_e64 v147, -v99, v43
    v_mul_f32 v132, v100, v36
    v_mul_f32_e64 v148, -v100, v44
    v_mul_f32 v133, v101, v37
    v_mul_f32_e64 v149, -v101, v45
    v_mfma_f32_32x32x16_bf16 v[112:127], v[76:79], v[12:15], v[112:127]
    v_mul_f32 v134, v102, v38
    v_mul_f32_e64 v150, -v102, v46
    v_mul_f32 v135, v103, v39
    v_mul_f32_e64 v151, -v103, v47
    v_mul_f32 v136, v104, v32
    v_mul_f32_e64 v152, -v104, v40
    v_mul_f32 v137, v105, v33
    v_mul_f32_e64 v153, -v105, v41
    v_mul_f32 v138, v106, v34
    v_mul_f32_e64 v154, -v106, v42
    v_mul_f32 v139, v107, v35
    v_mul_f32_e64 v155, -v107, v43
    v_mul_f32 v140, v108, v36
    v_mul_f32_e64 v156, -v108, v44
    v_mul_f32 v141, v109, v37
    v_mul_f32_e64 v157, -v109, v45
    v_mul_f32 v142, v110, v38
    v_mul_f32_e64 v158, -v110, v46
    v_mul_f32_e64 v143, v111, v39
    v_mul_f32_e64 v159, -v111, v47
    v_pk_fma_f32 v[128:129], v[112:113], v[40:41], v[128:129]
    v_pk_fma_f32 v[144:145], v[112:113], v[32:33], v[144:145]
    v_pk_fma_f32 v[130:131], v[114:115], v[42:43], v[130:131]
    v_pk_fma_f32 v[146:147], v[114:115], v[34:35], v[146:147]
    v_pk_fma_f32 v[132:133], v[116:117], v[44:45], v[132:133]
    v_pk_fma_f32 v[148:149], v[116:117], v[36:37], v[148:149]
    v_pk_fma_f32 v[134:135], v[118:119], v[46:47], v[134:135]
    v_pk_fma_f32 v[150:151], v[118:119], v[38:39], v[150:151]
    v_pk_fma_f32 v[136:137], v[120:121], v[40:41], v[136:137]
    v_pk_fma_f32 v[152:153], v[120:121], v[32:33], v[152:153]
    v_pk_fma_f32 v[138:139], v[122:123], v[42:43], v[138:139]
    v_pk_fma_f32 v[154:155], v[122:123], v[34:35], v[154:155]
    v_pk_fma_f32 v[140:141], v[124:125], v[44:45], v[140:141]
    v_pk_fma_f32 v[156:157], v[124:125], v[36:37], v[156:157]
    v_pk_fma_f32 v[142:143], v[126:127], v[46:47], v[142:143]
    v_pk_fma_f32 v[158:159], v[126:127], v[38:39], v[158:159]
    v_cvt_pk_bf16_f32 v160, v128, v129
    v_cvt_pk_bf16_f32 v161, v130, v131
    v_cvt_pk_bf16_f32 v162, v132, v133
    v_cvt_pk_bf16_f32 v163, v134, v135
    v_cvt_pk_bf16_f32 v164, v144, v145
    v_cvt_pk_bf16_f32 v165, v146, v147
    v_cvt_pk_bf16_f32 v166, v148, v149
    v_cvt_pk_bf16_f32 v167, v150, v151
    v_mfma_f32_32x32x16_bf16 v[64:79], v[160:163], v[48:51], 0
    v_cvt_pk_bf16_f32 v168, v136, v137
    v_cvt_pk_bf16_f32 v169, v138, v139
    v_cvt_pk_bf16_f32 v170, v140, v141
    v_cvt_pk_bf16_f32 v171, v142, v143
    v_mfma_f32_32x32x16_bf16 v[64:79], v[164:167], v[52:55], v[64:79]
    v_cvt_pk_bf16_f32 v172, v152, v153
    v_cvt_pk_bf16_f32 v173, v154, v155
    v_cvt_pk_bf16_f32 v174, v156, v157
    v_cvt_pk_bf16_f32 v175, v158, v159
    v_mfma_f32_32x32x16_bf16 v[64:79], v[168:171], v[56:59], v[64:79]
    s_nop 0
    v_mfma_f32_32x32x16_bf16 v[64:79], v[172:175], v[60:63], v[64:79]
    s_and_b32 s41, s40, 1
    s_lshl1_add_u32 s3, s7, s41
    s_lshl_b32 s3, s3, 6
    s_lshr_b32 s41, s40, 1
    s_add_u32 s3, s3, s41
    s_lshl_b32 s3, s3, 6
    v_and_b32 v255, 56, v0
    v_lshl_add_u32 v235, v237, 3, s3
    v_lshl_add_u32 v235, v255, 11, v235
    s_nop 1
    s_cmp_lg_u32 s6, 1
    s_cbranch_scc1 L_b_hd
    s_sub_u32 s3, s63, s40
    v_bfe_u32 v235, v0, 2, 1
    v_mul_u32_u24 v235, s3, v235
    v_add_u32 v235, s40, v235
    v_and_b32 v255, 15, v235
    v_and_b32 v235, 0xf0, v235
    v_lshlrev_b32 v235, 2, v235
    v_lshl_add_u32 v235, v255, 11, v235
    v_and_b32 v255, 10, v0
    v_lshl_add_u32 v235, v255, 2, v235
    v_and_b32 v255, 1, v0
    v_lshl_add_u32 v235, v255, 4, v235
    s_lshl_b32 s3, s7, 10
    s_add_u32 s3, s3, 131072
    v_add_u32 v235, s3, v235
L_b_hd:
    v_cvt_pk_bf16_f32 v80, v64, v65
    v_cvt_pk_bf16_f32 v81, v66, v67
    v_cvt_pk_bf16_f32 v82, v68, v69
    v_cvt_pk_bf16_f32 v83, v70, v71
    v_cvt_pk_bf16_f32 v84, v72, v73
    v_cvt_pk_bf16_f32 v85, v74, v75
    v_cvt_pk_bf16_f32 v86, v76, v77
    v_cvt_pk_bf16_f32 v87, v78, v79
    s_mov_b32 vcc_lo, 0x33333333
    s_mov_b32 vcc_hi, 0x33333333
    v_cndmask_b32_dpp v208, v84, v80, vcc quad_perm:[2,3,0,1] row_mask:0xf bank_mask:0xf
    v_cndmask_b32_dpp v209, v85, v81, vcc quad_perm:[2,3,0,1] row_mask:0xf bank_mask:0xf
    v_cndmask_b32_dpp v210, v86, v82, vcc quad_perm:[2,3,0,1] row_mask:0xf bank_mask:0xf
    v_cndmask_b32_dpp v211, v87, v83, vcc quad_perm:[2,3,0,1] row_mask:0xf bank_mask:0xf
    s_mov_b32 vcc_lo, 0xcccccccc
    s_mov_b32 vcc_hi, 0xcccccccc
    v_cndmask_b32_dpp v212, v80, v84, vcc quad_perm:[2,3,0,1] row_mask:0xf bank_mask:0xf
    v_cndmask_b32_dpp v213, v81, v85, vcc quad_perm:[2,3,0,1] row_mask:0xf bank_mask:0xf
    v_cndmask_b32_dpp v214, v82, v86, vcc quad_perm:[2,3,0,1] row_mask:0xf bank_mask:0xf
    v_cndmask_b32_dpp v215, v83, v87, vcc quad_perm:[2,3,0,1] row_mask:0xf bank_mask:0xf
    v_dot2_u32_u16 v216, v208, v208, 0
    v_dot2_u32_u16 v216, v209, v209, v216
    v_dot2_u32_u16 v216, v210, v210, v216
    v_dot2_u32_u16 v216, v211, v211, v216
    v_dot2_u32_u16 v217, v212, v212, 0
    v_dot2_u32_u16 v217, v213, v213, v217
    v_dot2_u32_u16 v217, v214, v214, v217
    v_dot2_u32_u16 v217, v215, v215, v217
    v_add_u32_dpp v216, v216, v216 quad_perm:[1,0,3,2] row_mask:0xf bank_mask:0xf
    s_nop 1
    v_add_u32_dpp v217, v217, v217 quad_perm:[1,0,3,2] row_mask:0xf bank_mask:0xf
    v_add_u32_dpp v216, v216, v216 quad_perm:[2,3,0,1] row_mask:0xf bank_mask:0xf
    s_nop 0
    v_add_u32_dpp v217, v217, v217 quad_perm:[2,3,0,1] row_mask:0xf bank_mask:0xf
    ds_write2_b32 v219, v216, v217 offset0:0 offset1:4
    v_lshlrev_b32 v219, 2, v1
    ds_write_b8 v244, v245 offset:28
    s_and_b32 s41, s5, 15
    s_lshr_b32 s43, s6, 1
    s_lshl1_add_u32 s3, s41, s43
    s_lshl_b32 s3, s3, 6
    s_and_b32 s51, s6, 1
    s_add_u32 s3, s3, s51
    s_lshl4_add_u32 s3, s3, 131072
    v_and_b32 v128, 3, v0
    v_lshl_add_u32 v128, v232, 2, v128
    v_lshl_add_u32 v128, v128, 6, s3
    v_and_b32 v129, 4, v0
    v_lshl_add_u32 v236, v129, 1, v128
    s_bfe_u32 s50, s5, 0x10002
    s_lshl1_add_u32 s3, s4, s50
    s_lshl2_add_u32 s3, s3, s6
    s_lshl_b32 s3, s3, 6
    s_add_u32 s3, s3, s7
    s_and_b32 s50, s5, 3
    s_lshl2_add_u32 s3, s3, s50
    s_lshl_b32 s3, s3, 3
    v_lshl_add_u32 v129, v232, 3, v237
    s_mov_b32 exec_lo, 0x00ff00ff
    s_mov_b32 exec_hi, 0x00ff00ff
    v_lshl_add_u32 v236, v129, 6, s3
    s_mov_b64 exec, -1
    s_add_u32 s60, s38, 262144
    s_addc_u32 s61, s39, 0
    s_and_b32 s3, s5, 7
    s_lshl1_add_u32 s3, s3, s51
    s_lshl_b32 s3, s3, 6
    s_add_u32 s3, s3, s43
    s_mul_i32 s3, s3, 2048
    s_lshl1_add_u32 s43, s4, s7
    s_lshl_b32 s50, s43, 7
    s_add_u32 s3, s3, s50
    s_add_u32 s3, s3, 4194304
    s_add_u32 s30, s38, s3
    s_addc_u32 s31, s39, 0
    s_lshl_b32 s50, s6, 12
    s_add_u32 s50, s50, 60672
    v_lshrrev_b32 v91, 3, v1
    v_mul_u32_u24 v91, 4096, v91
    v_lshl_add_u32 v91, v237, 4, v91
    v_add_u32 v90, s50, v243
    s_lshl_b32 s3, s4, 12
    s_add_u32 s3, s3, 4096
    s_add_u32 s58, s38, s3
    s_addc_u32 s59, s39, 0
    s_mov_b64 s[26:27], s[58:59]
    v_lshlrev_b32 v250, 7, v237
    s_lshl_b32 s3, s4, 7
    s_add_u32 s3, s3, 6144
    v_lshl_add_u32 v248, v237, 12, s3
    s_lshl_b32 s3, s41, 10
    s_lshl_b32 s41, s6, 18
    s_add_u32 s3, s3, s41
    s_lshl_b32 s43, s43, 6
    s_add_u32 s3, s3, s43
    s_nop 0
    v_lshl_add_u32 v234, v232, 16, s3
    v_lshl_add_u32 v234, v233, 2, v234
    v_add_u32 v239, 0x100000, v234
    s_mov_b32 s56, 0x4000
    s_mov_b32 s57, 0xc000
    s_mov_b32 s42, 0x8000
    v_mov_b64 v[40:41], v[88:89]
    v_mov_b64 v[42:43], v[90:91]
    v_mov_b64 v[44:45], v[92:93]
    v_mov_b32 v46, v94
    s_getreg_b32 s45, hwreg(HW_REG_XCC_ID, 0, 4)
    s_waitcnt lgkmcnt(0)
    s_branch L_b_tw
L_b_ts:
    s_sleep 1
L_b_tw:
    ds_read_b32 v146, v246 offset:0
    ds_read_b32 v253, v246 offset:16
    s_waitcnt lgkmcnt(0)
    v_cmp_eq_u32 vcc, 0, v146
    s_cbranch_vccnz L_b_ts
    v_xor_b32 v208, v253, v208
    v_xor_b32 v209, v253, v209
    v_xor_b32 v210, v253, v210
    v_xor_b32 v211, v253, v211
    v_xor_b32 v212, v253, v212
    v_xor_b32 v213, v253, v213
    v_xor_b32 v214, v253, v214
    v_xor_b32 v215, v253, v215
    v_readfirstlane_b32 s44, v253
    s_add_u32 s45, s45, 1
    s_add_u32 s45, s45, s44
    v_mov_b64 v[52:53], -1
    v_mov_b64 v[54:55], -1
    s_lshl2_add_u32 s3, s5, s6
    s_lshl_b32 s3, s3, 2
    v_mov_b32 v56, s3
    v_mov_b32 v57, s45
    s_mov_b64 s[22:23], s[52:53]
    s_mov_b64 s[20:21], s[54:55]
    s_cmp_eq_u32 s6, 1
    s_cselect_b32 s48, 0xffff, 0
    s_mov_b32 s49, 0
    s_cmp_lg_u32 s6, 0
    s_cbranch_scc1 L_b_kd
L_b_kw:
    ds_read_b32 v247, v246 offset:28
    s_waitcnt lgkmcnt(0)
    v_cmp_ne_u32 vcc, 0x01010101, v247
    s_cbranch_vccnz L_b_kw
    ds_read_b32 v216, v219 offset:50688
    ds_read_b32 v217, v219 offset:50944
    s_mov_b64 s[48:49], -1
    s_waitcnt lgkmcnt(0)
    v_add_u32 v252, v216, v217
L_b_kd:
    s_setprio 3
    s_barrier
    global_store_dwordx4 v238, v[208:211], s[28:29] offset:0 sc1
    global_store_dwordx4 v238, v[212:215], s[28:29] offset:128 sc1
    s_cmp_ge_u32 s6, 2
    s_cbranch_scc1 L_b_ng
    s_mov_b64 exec, s[48:49]
    global_store_dwordx2 v235, v[252:253], s[60:61] sc1
    s_mov_b64 exec, -1
L_b_ng:
    s_xor_b32 s3, s6, 2
    s_or_b32 s3, s5, s3
    s_cbranch_scc1 L_b_postd
    s_mov_b64 exec, 0xff
    global_store_dword v248, v253, s[38:39] sc1
    s_mov_b64 exec, -1
L_b_postd:
    ds_read_b32 v147, v246 offset:20
    s_waitcnt lgkmcnt(0)
    v_cmp_ne_u32 vcc, 0, v147
    s_cbranch_vccnz L_b_far
L_b_fard:
    s_mov_b32 s98, 0
    s_nop 0
    v_add_u32 v49, 32768, v43
    v_add_u32 v50, 65536, v43
    v_add_u32 v51, 98304, v43
    global_store_dwordx4 v44, v[52:55], s[22:23]
    global_store_dwordx4 v44, v[52:55], s[20:21] offset:1024
    s_setprio 0
    s_lshl_b32 s3, s6, 5
    s_bfe_u32 s41, s5, 0x10003
    s_add_u32 s3, s3, s41
    v_lshl_add_u32 v128, v233, 1, s3
    v_cvt_f32_u32 v128, v128
    v_mul_f32 v131, 0x3b800000, v128
    v_cvt_f32_u32 v129, v232
    v_mul_f32 v129, 4.0, v129
    v_mul_f32 v132, v129, v131
    v_cos_f32 v134, v132
    v_sin_f32 v135, v132
    v_add_f32 v132, v132, v131
    v_cvt_pk_bf16_f32 v176, v134, v135
    v_cos_f32 v134, v132
    v_sin_f32 v135, v132
    v_add_f32 v132, v132, v131
    v_cvt_pk_bf16_f32 v184, v134, v135
    v_cos_f32 v134, v132
    v_sin_f32 v135, v132
    v_add_f32 v132, v132, v131
    v_cvt_pk_bf16_f32 v177, v134, v135
    v_cos_f32 v134, v132
    v_sin_f32 v135, v132
    v_fmamk_f32 v132, v131, 0x41500000, v132
    v_cvt_pk_bf16_f32 v185, v134, v135
    s_setprio 3
    s_nop 0
    buffer_load_dword v4, v234, s[8:11], 0 offen
    buffer_load_dword v5, v234, s[8:11], s56 offen
    buffer_load_dword v6, v234, s[8:11], s42 offen
    buffer_load_dword v7, v234, s[8:11], s57 offen
    buffer_load_dword v8, v239, s[8:11], 0 offen
    buffer_load_dword v9, v239, s[8:11], s56 offen
    buffer_load_dword v10, v239, s[8:11], s42 offen
    buffer_load_dword v11, v239, s[8:11], s57 offen
    s_setprio 0
    v_cos_f32 v134, v132
    v_sin_f32 v135, v132
    v_add_f32 v132, v132, v131
    v_cvt_pk_bf16_f32 v178, v134, v135
    v_cos_f32 v134, v132
    v_sin_f32 v135, v132
    v_add_f32 v132, v132, v131
    v_cvt_pk_bf16_f32 v186, v134, v135
    v_cos_f32 v134, v132
    v_sin_f32 v135, v132
    v_add_f32 v132, v132, v131
    v_cvt_pk_bf16_f32 v179, v134, v135
    v_cos_f32 v134, v132
    v_sin_f32 v135, v132
    v_fmamk_f32 v132, v131, 0x41500000, v132
    v_cvt_pk_bf16_f32 v187, v134, v135
    v_cos_f32 v134, v132
    v_sin_f32 v135, v132
    v_add_f32 v132, v132, v131
    v_cvt_pk_bf16_f32 v180, v134, v135
    v_cos_f32 v134, v132
    v_sin_f32 v135, v132
    v_add_f32 v132, v132, v131
    v_cvt_pk_bf16_f32 v188, v134, v135
    v_cos_f32 v134, v132
    v_sin_f32 v135, v132
    v_add_f32 v132, v132, v131
    v_cvt_pk_bf16_f32 v181, v134, v135
    v_cos_f32 v134, v132
    v_sin_f32 v135, v132
    v_fmamk_f32 v132, v131, 0x41500000, v132
    v_cvt_pk_bf16_f32 v189, v134, v135
    v_cos_f32 v134, v132
    v_sin_f32 v135, v132
    v_add_f32 v132, v132, v131
    v_cvt_pk_bf16_f32 v182, v134, v135
    v_cos_f32 v134, v132
    v_sin_f32 v135, v132
    v_add_f32 v132, v132, v131
    v_cvt_pk_bf16_f32 v190, v134, v135
    v_cos_f32 v134, v132
    v_sin_f32 v135, v132
    v_add_f32 v132, v132, v131
    v_cvt_pk_bf16_f32 v183, v134, v135
    v_cos_f32 v134, v132
    v_sin_f32 v135, v132
    s_nop 0
    v_cvt_pk_bf16_f32 v191, v134, v135
    s_bfe_u32 s41, s5, 0x10003
    s_lshl_b32 s3, s41, 4
    s_lshl_b32 s43, s41, 15
    v_bfe_i32 v133, v0, 0, 1
    v_and_b32 v133, 0x80008000, v133
    v_xor_b32 v133, s43, v133
    v_alignbit_b32 v192, v176, v176, s3
    v_xor_b32 v192, v133, v192
    v_alignbit_b32 v193, v177, v177, s3
    v_xor_b32 v193, v133, v193
    v_alignbit_b32 v194, v178, v178, s3
    v_xor_b32 v194, v133, v194
    v_alignbit_b32 v195, v179, v179, s3
    v_xor_b32 v195, v133, v195
    v_alignbit_b32 v196, v180, v180, s3
    v_xor_b32 v196, v133, v196
    v_alignbit_b32 v197, v181, v181, s3
    v_xor_b32 v197, v133, v197
    v_alignbit_b32 v198, v182, v182, s3
    v_xor_b32 v198, v133, v198
    v_alignbit_b32 v199, v183, v183, s3
    v_xor_b32 v199, v133, v199
    v_alignbit_b32 v200, v184, v184, s3
    v_xor_b32 v200, v133, v200
    v_alignbit_b32 v201, v185, v185, s3
    v_xor_b32 v201, v133, v201
    v_alignbit_b32 v202, v186, v186, s3
    v_xor_b32 v202, v133, v202
    v_alignbit_b32 v203, v187, v187, s3
    v_xor_b32 v203, v133, v203
    v_alignbit_b32 v204, v188, v188, s3
    v_xor_b32 v204, v133, v204
    v_alignbit_b32 v205, v189, v189, s3
    v_xor_b32 v205, v133, v205
    v_alignbit_b32 v206, v190, v190, s3
    v_xor_b32 v206, v133, v206
    v_alignbit_b32 v207, v191, v191, s3
    v_xor_b32 v207, v133, v207
    s_lshl_b32 s41, s41, 31
    s_or_b32 s41, s41, 0x3f803f80
    s_mov_b64 exec, 0xffff
    v_mov_b32 v176, s41
    s_mov_b64 exec, -1
    s_setprio 3
    s_waitcnt vmcnt(8)
    s_mov_b64 exec, 1
    global_store_dword v56, v57, s[26:27] offset:1024
    s_mov_b64 exec, -1
    global_load_dword v147, v250, s[26:27] offset:2048 sc1
    global_load_dwordx2 v[144:145], v236, s[60:61] sc1
    s_mov_b32 s3, 0
L_b_pv:
    s_waitcnt vmcnt(0)
    v_cmp_ne_u32 vcc, s44, v147
    s_cbranch_vccz L_b_pv_ok
    s_mov_b64 exec, vcc
    s_sleep 2
    global_load_dword v147, v250, s[26:27] offset:2048 sc1
    s_add_u32 s3, s3, 1
    s_cmp_lt_u32 s3, 40000
    s_cbranch_scc1 L_b_pv
    s_waitcnt vmcnt(0)
L_b_pv_ok:
    s_mov_b64 exec, -1
L_b_vf:
    v_cmp_ne_u32 vcc, s44, v145
    s_cbranch_vccz L_b_gok
    s_mov_b64 exec, vcc
    global_load_dwordx2 v[144:145], v236, s[60:61] sc1
    s_mov_b64 exec, -1
L_b_fast:
L_b_gok:
    s_or_b32 s43, s2, s6
    s_cbranch_scc1 L_b_epd
    s_mov_b64 exec, 1
    global_store_dword v246, v253, s[38:39] sc1
    s_mov_b64 exec, -1
L_b_epd:
    global_load_dwordx4 v[64:67], v43, s[30:31] sc1
    global_load_dwordx4 v[68:71], v49, s[30:31] sc1
    global_load_dwordx4 v[72:75], v50, s[30:31] sc1
    global_load_dwordx4 v[76:79], v51, s[30:31] sc1
    v_lshlrev_b32 v16, 16, v4
    v_and_b32 v17, 0xffff0000, v4
    v_lshlrev_b32 v18, 16, v5
    v_and_b32 v19, 0xffff0000, v5
    v_lshlrev_b32 v20, 16, v6
    v_and_b32 v21, 0xffff0000, v6
    v_lshlrev_b32 v22, 16, v7
    v_and_b32 v23, 0xffff0000, v7
    v_lshlrev_b32 v24, 16, v8
    v_and_b32 v25, 0xffff0000, v8
    v_lshlrev_b32 v26, 16, v9
    v_and_b32 v27, 0xffff0000, v9
    v_lshlrev_b32 v28, 16, v10
    v_and_b32 v29, 0xffff0000, v10
    v_lshlrev_b32 v30, 16, v11
    v_and_b32 v31, 0xffff0000, v11
    v_mov_b32 v146, 0
    s_waitcnt vmcnt(4)
    v_cmp_ne_u32 s[48:49], s44, v145
    s_mov_b32 exec_lo, 0x00ff00ff
    s_mov_b32 exec_hi, 0x00ff00ff
    v_sub_u32 v146, 0, v144
    s_mov_b64 exec, -1
    v_lshlrev_b32 v149, 16, v144
    v_and_b32 v148, 0xffff0000, v144
    s_nop 1
    s_nop 0
    v_mul_f32_dpp v16, v148, v16 row_newbcast:8 row_mask:0xf bank_mask:0xf
    v_mul_f32_dpp v17, v148, v17 row_newbcast:8 row_mask:0xf bank_mask:0xf
    v_mul_f32_dpp v18, v148, v18 row_newbcast:9 row_mask:0xf bank_mask:0xf
    v_mul_f32_dpp v19, v148, v19 row_newbcast:9 row_mask:0xf bank_mask:0xf
    v_mul_f32_dpp v20, v148, v20 row_newbcast:10 row_mask:0xf bank_mask:0xf
    v_mul_f32_dpp v21, v148, v21 row_newbcast:10 row_mask:0xf bank_mask:0xf
    v_mul_f32_dpp v22, v148, v22 row_newbcast:11 row_mask:0xf bank_mask:0xf
    v_mul_f32_dpp v23, v148, v23 row_newbcast:11 row_mask:0xf bank_mask:0xf
    v_mul_f32_dpp v24, v148, v24 row_newbcast:12 row_mask:0xf bank_mask:0xf
    v_mul_f32_dpp v25, v148, v25 row_newbcast:12 row_mask:0xf bank_mask:0xf
    v_mul_f32_dpp v26, v148, v26 row_newbcast:13 row_mask:0xf bank_mask:0xf
    v_mul_f32_dpp v27, v148, v27 row_newbcast:13 row_mask:0xf bank_mask:0xf
    v_mul_f32_dpp v28, v148, v28 row_newbcast:14 row_mask:0xf bank_mask:0xf
    v_mul_f32_dpp v29, v148, v29 row_newbcast:14 row_mask:0xf bank_mask:0xf
    v_mul_f32_dpp v30, v148, v30 row_newbcast:15 row_mask:0xf bank_mask:0xf
    v_mul_f32_dpp v31, v148, v31 row_newbcast:15 row_mask:0xf bank_mask:0xf
    s_waitcnt vmcnt(3)
    v_xor_b32 v64, v253, v64
    v_xor_b32 v65, v253, v65
    v_xor_b32 v66, v253, v66
    v_xor_b32_e64 v67, v253, v67
    ds_write_b128 v42, v[64:67] offset:0
    v_dot2_u32_u16 v146, v64, v64, v146
    v_dot2_u32_u16 v146, v65, v65, v146
    v_dot2_u32_u16 v146, v66, v66, v146
    v_dot2_u32_u16 v146, v67, v67, v146
    s_waitcnt vmcnt(2)
    v_xor_b32 v68, v253, v68
    v_xor_b32 v69, v253, v69
    v_xor_b32 v70, v253, v70
    v_xor_b32_e64 v71, v253, v71
    ds_write_b128 v42, v[68:71] offset:1024
    v_dot2_u32_u16 v146, v68, v68, v146
    v_dot2_u32_u16 v146, v69, v69, v146
    v_dot2_u32_u16 v146, v70, v70, v146
    v_dot2_u32_u16 v146, v71, v71, v146
    s_waitcnt vmcnt(1)
    v_xor_b32 v72, v253, v72
    v_xor_b32 v73, v253, v73
    v_xor_b32 v74, v253, v74
    v_xor_b32_e64 v75, v253, v75
    ds_write_b128 v42, v[72:75] offset:2048
    v_dot2_u32_u16 v146, v72, v72, v146
    v_dot2_u32_u16 v146, v73, v73, v146
    v_dot2_u32_u16 v146, v74, v74, v146
    v_dot2_u32_u16 v146, v75, v75, v146
    s_waitcnt vmcnt(0)
    v_xor_b32 v76, v253, v76
    v_xor_b32 v77, v253, v77
    v_xor_b32 v78, v253, v78
    v_xor_b32_e64 v79, v253, v79
    ds_write_b128 v42, v[76:79] offset:3072
    v_dot2_u32_u16 v146, v76, v76, v146
    v_dot2_u32_u16 v146, v77, v77, v146
    v_dot2_u32_u16 v146, v78, v78, v146
    v_dot2_u32_u16 v146, v79, v79, v146
    s_nop 2
    v_add_u32_dpp v146, v146, v146 row_ror:8 row_mask:0xf bank_mask:0xf
    s_nop 1
    v_add_u32_dpp v146, v146, v146 row_ror:4 row_mask:0xf bank_mask:0xf
    s_nop 1
    v_add_u32_dpp v146, v146, v146 row_ror:2 row_mask:0xf bank_mask:0xf
    s_nop 1
    v_add_u32_dpp v146, v146, v146 row_ror:1 row_mask:0xf bank_mask:0xf
    s_nop 0
    v_readlane_b32 s40, v146, 0
    v_readlane_b32 s41, v146, 16
    v_readlane_b32 s43, v146, 32
    v_readlane_b32 s51, v146, 48
    s_add_u32 s40, s40, s41
    s_add_u32 s43, s43, s51
    s_add_u32 s40, s40, s43
    s_or_b32 s48, s48, s40
    s_or_b32 s48, s48, s49
    s_cbranch_scc1 L_b_vr
L_b_vok:
    ds_write_b8 v244, v245 offset:8
    s_lshl_b32 s43, s6, 11
    s_add_u32 m0, s43, 9216
    s_setprio 0
    s_branch L_b_vw
L_b_vs:
    s_sleep 1
L_b_vw:
    ds_read2_b32 v[54:55], v246 offset0:1 offset1:2
    s_waitcnt lgkmcnt(0)
    v_and_b32 v54, v54, v55
    v_cmp_ne_u32 vcc, 0x01010101, v54
    s_cbranch_vccnz L_b_vs
    ds_read_b64_tr_b16 v[64:65], v40 offset:0
    ds_read_b64_tr_b16 v[66:67], v40 offset:1024
    ds_read_b64_tr_b16 v[68:69], v40 offset:2048
    ds_read_b64_tr_b16 v[70:71], v40 offset:3072
    ds_read_b64_tr_b16 v[72:73], v40 offset:4096
    ds_read_b64_tr_b16 v[74:75], v40 offset:5120
    ds_read_b64_tr_b16 v[76:77], v40 offset:6144
    ds_read_b64_tr_b16 v[78:79], v40 offset:7168
    ds_read_b64_tr_b16 v[80:81], v40 offset:8192
    ds_read_b64_tr_b16 v[82:83], v40 offset:9216
    ds_read_b64_tr_b16 v[84:85], v40 offset:10240
    ds_read_b64_tr_b16 v[86:87], v40 offset:11264
    ds_read_b64_tr_b16 v[88:89], v40 offset:12288
    ds_read_b64_tr_b16 v[90:91], v40 offset:13312
    s_waitcnt lgkmcnt(10)
    s_nop 0
    v_mfma_f32_16x16x32_bf16 v[128:131], v[176:179], v[64:67], 0
    ds_read_b64_tr_b16 v[92:93], v40 offset:14336
    ds_read_b64_tr_b16 v[94:95], v40 offset:15360
    v_mfma_f32_16x16x32_bf16 v[128:131], v[180:183], v[68:71], v[128:131]
    ds_read_b64_tr_b16 v[96:97], v41 offset:0
    ds_read_b64_tr_b16 v[98:99], v41 offset:1024
    global_load_lds_dwordx4 v44, s[52:53] sc1
    global_load_lds_dwordx4 v44, s[54:55] offset:1024 sc1
    s_waitcnt lgkmcnt(10)
    s_nop 0
    v_mfma_f32_16x16x32_bf16 v[128:131], v[192:195], v[72:75], v[128:131]
    ds_read_b64_tr_b16 v[100:101], v41 offset:2048
    ds_read_b64_tr_b16 v[102:103], v41 offset:3072
    v_mfma_f32_16x16x32_bf16 v[128:131], v[196:199], v[76:79], v[128:131]
    ds_read_b64_tr_b16 v[104:105], v41 offset:4096
    ds_read_b64_tr_b16 v[106:107], v41 offset:5120
    s_waitcnt lgkmcnt(10)
    s_nop 0
    v_mfma_f32_16x16x32_bf16 v[132:135], v[184:187], v[80:83], 0
    ds_read_b64_tr_b16 v[108:109], v41 offset:6144
    ds_read_b64_tr_b16 v[110:111], v41 offset:7168
    v_mfma_f32_16x16x32_bf16 v[132:135], v[188:191], v[84:87], v[132:135]
    ds_read_b64_tr_b16 v[112:113], v41 offset:8192
    ds_read_b64_tr_b16 v[114:115], v41 offset:9216
    s_waitcnt lgkmcnt(10)
    s_nop 0
    v_mfma_f32_16x16x32_bf16 v[132:135], v[200:203], v[88:91], v[132:135]
    ds_read_b64_tr_b16 v[116:117], v41 offset:10240
    ds_read_b64_tr_b16 v[118:119], v41 offset:11264
    v_mfma_f32_16x16x32_bf16 v[132:135], v[204:207], v[92:95], v[132:135]
    ds_read_b64_tr_b16 v[120:121], v41 offset:12288
    ds_read_b64_tr_b16 v[122:123], v41 offset:13312
    s_waitcnt lgkmcnt(12)
    v_mfma_f32_16x16x32_bf16 v[136:139], v[176:179], v[96:99], 0
    ds_read_b64_tr_b16 v[124:125], v41 offset:14336
    ds_read_b64_tr_b16 v[126:127], v41 offset:15360
    s_waitcnt lgkmcnt(12)
    v_mfma_f32_16x16x32_bf16 v[136:139], v[180:183], v[100:103], v[136:139]
    s_waitcnt lgkmcnt(10)
    v_mfma_f32_16x16x32_bf16 v[136:139], v[192:195], v[104:107], v[136:139]
    s_waitcnt lgkmcnt(8)
    v_mfma_f32_16x16x32_bf16 v[136:139], v[196:199], v[108:111], v[136:139]
    v_add_f32 v160, v128, v132
    v_sub_f32 v168, v128, v132
    s_waitcnt lgkmcnt(6)
    v_mfma_f32_16x16x32_bf16 v[140:143], v[184:187], v[112:115], 0
    v_add_f32 v162, v129, v133
    v_sub_f32 v170, v129, v133
    s_waitcnt lgkmcnt(4)
    v_mfma_f32_16x16x32_bf16 v[140:143], v[188:191], v[116:119], v[140:143]
    v_add_f32 v164, v130, v134
    v_sub_f32 v172, v130, v134
    s_waitcnt lgkmcnt(2)
    v_mfma_f32_16x16x32_bf16 v[140:143], v[200:203], v[120:123], v[140:143]
    v_add_f32 v166, v131, v135
    v_sub_f32 v174, v131, v135
    s_waitcnt lgkmcnt(0)
    v_mfma_f32_16x16x32_bf16 v[140:143], v[204:207], v[124:127], v[140:143]
    v_mul_f32_dpp v160, v149, v160 row_newbcast:8 row_mask:0xf bank_mask:0xf
    v_mul_f32_dpp v162, v149, v162 row_newbcast:9 row_mask:0xf bank_mask:0xf
    v_mul_f32_dpp v164, v149, v164 row_newbcast:10 row_mask:0xf bank_mask:0xf
    v_mul_f32_dpp v166, v149, v166 row_newbcast:11 row_mask:0xf bank_mask:0xf
    v_mul_f32_dpp v168, v149, v168 row_newbcast:12 row_mask:0xf bank_mask:0xf
    v_mul_f32_dpp v170, v149, v170 row_newbcast:13 row_mask:0xf bank_mask:0xf
    v_mul_f32_dpp v172, v149, v172 row_newbcast:14 row_mask:0xf bank_mask:0xf
    v_mul_f32_dpp v174, v149, v174 row_newbcast:15 row_mask:0xf bank_mask:0xf
    s_mov_b32 s97, 0
    s_waitcnt vmcnt(0)
    ds_read_b128 v[56:59], v45 offset:9216
    ds_read_b128 v[60:63], v45 offset:10240
    v_add_f32 v161, v136, v140
    v_sub_f32 v169, v136, v140
    v_add_f32 v163, v137, v141
    v_sub_f32 v171, v137, v141
    v_add_f32 v165, v138, v142
    v_sub_f32 v173, v138, v142
    v_add_f32 v167, v139, v143
    v_sub_f32 v175, v139, v143
    v_mul_f32_dpp v161, v149, v161 row_newbcast:8 row_mask:0xf bank_mask:0xf
    v_mul_f32_dpp v163, v149, v163 row_newbcast:9 row_mask:0xf bank_mask:0xf
    v_mul_f32_dpp v165, v149, v165 row_newbcast:10 row_mask:0xf bank_mask:0xf
    v_mul_f32_dpp v167, v149, v167 row_newbcast:11 row_mask:0xf bank_mask:0xf
    v_mul_f32_dpp v169, v149, v169 row_newbcast:12 row_mask:0xf bank_mask:0xf
    v_mul_f32_dpp v171, v149, v171 row_newbcast:13 row_mask:0xf bank_mask:0xf
    v_mul_f32_dpp v173, v149, v173 row_newbcast:14 row_mask:0xf bank_mask:0xf
    v_mul_f32_dpp v175, v149, v175 row_newbcast:15 row_mask:0xf bank_mask:0xf
    s_cmp_eq_u32 s44, s45
    s_cbranch_scc1 L_b_yf
L_b_yc:
    s_waitcnt lgkmcnt(0)
    v_max3_u32 v47, v56, v57, v58
    v_max3_u32 v48, v59, v60, v61
    v_max3_u32 v47, v47, v62, v63
    v_max_u32 v47, v47, v48
    v_cmp_eq_u32 vcc, -1, v47
    s_cbranch_vccz L_b_yok
    global_load_lds_dwordx4 v44, s[52:53] sc1
    global_load_lds_dwordx4 v44, s[54:55] offset:1024 sc1
    s_add_u32 s97, s97, 1
    s_cmp_ge_u32 s97, 64
    s_cbranch_scc1 L_b_yf
    s_waitcnt vmcnt(0)
    ds_read_b128 v[56:59], v45 offset:9216
    ds_read_b128 v[60:63], v45 offset:10240
    s_branch L_b_yc
L_b_yok:
    v_lshlrev_b32 v72, 16, v56
    v_and_b32 v73, 0xffff0000, v56
    v_pk_fma_f32 v[160:161], v[16:17], v[72:73], v[160:161]
    v_cvt_pk_bf16_f32 v96, v160, v161
    buffer_store_dword v96, v234, s[12:15], 0 offen
    v_lshlrev_b32 v74, 16, v57
    v_and_b32 v75, 0xffff0000, v57
    v_pk_fma_f32 v[162:163], v[18:19], v[74:75], v[162:163]
    v_cvt_pk_bf16_f32 v97, v162, v163
    buffer_store_dword v97, v234, s[12:15], s56 offen
    v_lshlrev_b32 v76, 16, v58
    v_and_b32 v77, 0xffff0000, v58
    v_pk_fma_f32 v[164:165], v[20:21], v[76:77], v[164:165]
    v_cvt_pk_bf16_f32 v98, v164, v165
    buffer_store_dword v98, v234, s[12:15], s42 offen
    v_lshlrev_b32 v78, 16, v59
    v_and_b32 v79, 0xffff0000, v59
    v_pk_fma_f32 v[166:167], v[22:23], v[78:79], v[166:167]
    v_cvt_pk_bf16_f32 v99, v166, v167
    buffer_store_dword v99, v234, s[12:15], s57 offen
    v_lshlrev_b32 v80, 16, v60
    v_and_b32 v81, 0xffff0000, v60
    v_pk_fma_f32 v[168:169], v[24:25], v[80:81], v[168:169]
    v_cvt_pk_bf16_f32 v100, v168, v169
    buffer_store_dword v100, v239, s[12:15], 0 offen
    v_lshlrev_b32 v82, 16, v61
    v_and_b32 v83, 0xffff0000, v61
    v_pk_fma_f32 v[170:171], v[26:27], v[82:83], v[170:171]
    v_cvt_pk_bf16_f32 v101, v170, v171
    buffer_store_dword v101, v239, s[12:15], s56 offen
    v_lshlrev_b32 v84, 16, v62
    v_and_b32 v85, 0xffff0000, v62
    v_pk_fma_f32 v[172:173], v[28:29], v[84:85], v[172:173]
    v_cvt_pk_bf16_f32 v102, v172, v173
    buffer_store_dword v102, v239, s[12:15], s42 offen
    v_lshlrev_b32 v86, 16, v63
    v_and_b32 v87, 0xffff0000, v63
    v_pk_fma_f32 v[174:175], v[30:31], v[86:87], v[174:175]
    v_cvt_pk_bf16_f32 v103, v174, v175
    buffer_store_dword v103, v239, s[12:15], s57 offen
L_end:
    s_endpgm
L_a_far:
    s_mov_b64 exec, -1
    s_add_u32 s31, s31, 8388608
    s_add_u32 s54, s38, s31
    s_addc_u32 s55, s39, 0
    global_store_dwordx4 v8, v[240:243], s[54:55] sc1
    global_store_dwordx4 v8, v[244:247], s[54:55] offset:64 sc1
    buffer_wbl2 sc1
    s_add_u32 s14, s58, 65536
    s_addc_u32 s15, s59, 0
    s_waitcnt vmcnt(0)
    s_mov_b64 exec, 1
    global_store_dword v7, v27, s[14:15] sc1
    s_mov_b64 exec, -1
L_a_pf:
    global_load_dwordx2 v[24:25], v20, s[14:15] sc1
    s_waitcnt vmcnt(0)
    global_load_dwordx2 v[22:23], v20, s[58:59] sc1
    s_waitcnt vmcnt(0)
    v_cmp_ne_u32 vcc, s45, v22
    v_cmp_ne_u32 s[40:41], s45, v23
    s_nop 0
    s_or_b64 vcc, vcc, s[40:41]
    s_cbranch_scc0 L_a_pu_ok
    v_cmp_ne_u32 vcc, s44, v24
    v_cmp_ne_u32 s[40:41], s44, v25
    s_nop 0
    s_or_b64 vcc, vcc, s[40:41]
    s_cbranch_scc0 L_a_isfar
    s_sleep 8
    s_add_u32 s3, s3, 1
    s_cmp_lt_u32 s3, 40000
    s_cbranch_scc1 L_a_pf
L_a_isfar:
    s_mov_b32 s96, 1
    v_mov_b32 v9, s44
    v_mov_b32 v28, 1
    ds_write_b32 v26, v28 offset:20
    s_waitcnt lgkmcnt(0)
    s_add_u32 s30, s30, 8388608
    s_add_u32 s33, s33, 10485760
    s_add_u32 s52, s38, s30
    s_addc_u32 s53, s39, 0
    s_add_u32 s56, s52, 0x3fc00
    s_addc_u32 s57, s53, 0
    s_add_u32 s16, s38, s33
    s_addc_u32 s17, s39, 0
    s_branch L_a_pu_ok
L_a_yfar:
    s_waitcnt lgkmcnt(4)
    v_add_f32 v32, v32, v36
    v_add_f32 v33, v33, v37
    v_add_f32 v34, v34, v38
    v_add_f32 v35, v35, v39
    v_add_f32 v40, v40, v44
    v_add_f32 v41, v41, v45
    v_add_f32 v42, v42, v46
    v_add_f32_e64 v43, v43, v47
    v_cvt_pk_bf16_f32 v64, v32, v40
    v_cvt_pk_bf16_f32 v65, v33, v41
    v_cvt_pk_bf16_f32 v66, v34, v42
    v_cvt_pk_bf16_f32 v67, v35, v43
    global_store_dwordx4 v19, v[64:67], s[16:17] offset:0 sc1
    s_waitcnt lgkmcnt(0)
    v_add_f32 v48, v48, v52
    v_add_f32 v49, v49, v53
    v_add_f32 v50, v50, v54
    v_add_f32 v51, v51, v55
    v_add_f32 v56, v56, v60
    v_add_f32 v57, v57, v61
    v_add_f32 v58, v58, v62
    v_add_f32_e64 v59, v59, v63
    v_cvt_pk_bf16_f32 v68, v48, v56
    v_cvt_pk_bf16_f32 v69, v49, v57
    v_cvt_pk_bf16_f32 v70, v50, v58
    v_cvt_pk_bf16_f32 v71, v51, v59
    global_store_dwordx4 v19, v[68:71], s[16:17] offset:2048 sc1
    s_waitcnt vmcnt(0)
    s_mov_b64 exec, 1
    global_store_dword v29, v9, s[14:15] offset:512 sc1
    s_branch L_a_done
L_a_ww:
    s_mov_b32 s3, 0
L_a_wp:
    global_load_dword v31, v30, s[58:59] offset:1024 sc1
    s_waitcnt vmcnt(0)
    v_cmp_ne_u32 vcc, v9, v31
    s_cbranch_vccz L_a_wok
    s_add_u32 s3, s3, 1
    s_cmp_lt_u32 s3, 40000
    s_cbranch_scc1 L_a_wp
    s_branch L_a_wok
L_b_s0:
    v_cmp_eq_u32 vcc, 0, v167
    s_nop 1
    v_cndmask_b32 v56, v48, v167, vcc
    v_cndmask_b32 v48, 0, v48, vcc
    v_cndmask_b32 v57, v49, v167, vcc
    v_cndmask_b32 v49, 0, v49, vcc
    v_cndmask_b32 v58, v50, v167, vcc
    v_cndmask_b32 v50, 0, v50, vcc
    v_cndmask_b32 v59, v51, v167, vcc
    v_cndmask_b32 v51, 0, v51, vcc
    v_cndmask_b32 v60, v52, v167, vcc
    v_cndmask_b32 v52, 0, v52, vcc
    v_cndmask_b32 v61, v53, v167, vcc
    v_cndmask_b32 v53, 0, v53, vcc
    v_cndmask_b32 v62, v54, v167, vcc
    v_cndmask_b32 v54, 0, v54, vcc
    v_cndmask_b32 v63, v55, v167, vcc
    v_cndmask_b32 v55, 0, v55, vcc
    s_branch L_b_s0back
L_b_far:
    s_mov_b32 s45, s44
    s_add_u32 s24, s24, 10485760
    s_add_u32 s52, s38, s24
    s_addc_u32 s53, s39, 0
    s_add_u32 s54, s52, 0xffc00
    s_addc_u32 s55, s53, 0
    s_add_u32 s58, s58, 65536
    s_addc_u32 s59, s59, 0
    s_branch L_b_fard
L_b_vr:
    s_add_u32 s98, s98, 1
    s_cmp_lt_u32 s98, 2500
    s_cbranch_scc0 L_b_vok
    s_sleep 2
    s_branch L_b_vf
L_b_yf:
    s_mov_b32 s3, 0
L_b_py:
    global_load_dword v47, v46, s[58:59] offset:512 sc1
    s_waitcnt vmcnt(0)
    v_cmp_ne_u32 vcc, s45, v47
    s_cbranch_vccz L_b_py_ok
    s_add_u32 s3, s3, 1
    s_cmp_lt_u32 s3, 40000
    s_cbranch_scc1 L_b_py
L_b_py_ok:
    s_waitcnt lgkmcnt(0)
    global_load_lds_dwordx4 v44, s[52:53] sc1
    global_load_lds_dwordx4 v44, s[54:55] offset:1024 sc1
    s_waitcnt vmcnt(0)
    ds_read_b128 v[56:59], v45 offset:9216
    ds_read_b128 v[60:63], v45 offset:10240
    s_waitcnt lgkmcnt(0)
    s_branch L_b_yok
.p2align 8
.fill 1536, 4, 0xbf810000
.section .rodata,"a"
.p2align 6
.amdhsa_kernel gated_mix__ssm_conv_h3__spectral_fnet__prompt_kernel
.amdhsa_next_free_vgpr 256
.amdhsa_next_free_sgpr 102
.amdhsa_accum_offset 256
.amdhsa_group_segment_fixed_size 0
.amdhsa_kernarg_size 120
.amdhsa_user_sgpr_count 2
.amdhsa_user_sgpr_kernarg_segment_ptr 1
.amdhsa_system_sgpr_workgroup_id_x 1
.end_amdhsa_kernel
```
